```python
import torch

def _softmax(x, axis=-1):
    return torch.softmax(x, dim=axis)
def _gelu(x):
    return torch.nn.functional.gelu(x, approximate="tanh")
def _silu(x):
    return torch.nn.functional.silu(x)
def _sigmoid(x):
    return torch.sigmoid(x)
def _layernorm(x, axis=-1, eps=1e-5):
    m = x.mean(dim=axis, keepdim=True)
    v = x.var(dim=axis, keepdim=True, unbiased=False)
    return (x - m) / torch.sqrt(v + eps)
def _scatter_add(tgt, idx, src, axis=0):
    return tgt.clone().index_add_(axis, idx, src)
def _segment_sum(src, seg, n):
    out = torch.zeros((n,) + src.shape[1:], dtype=src.dtype)
    return out.index_add_(0, seg, src)
def _pad(x, pw):
    flat = tuple(v for pair in reversed(pw) for v in pair)
    return torch.nn.functional.pad(x, flat)

kernel_name = 'sequential_preLN__spectral_gfnet__mixer_token_mlp__prompt'

def setup_inputs():

    _w = (lambda a: (lambda t: t.to(torch.bfloat16) if t.is_floating_point() else t)(torch.as_tensor(a)))
    def _A_setup():
        B, S, D = 1, 2048, 448
        Df = D // 2 + 1
        return {
            "x": _w((lambda *s: torch.randn(*s, dtype=torch.bfloat16) * 0.05)(B, S, D)),
            "w_r": _w((lambda *s: torch.randn(*s, dtype=torch.bfloat16) * 0.4)(S, Df) * 0.02),
            "w_i": _w((lambda *s: torch.randn(*s, dtype=torch.bfloat16) * 0.4)(S, Df) * 0.02),
        }
    _A_in = _A_setup()

    def _B_setup():
        B, S, D, F = 1, 2048, 448, 1792
        return {
            "x": _w((lambda *s: torch.randn(*s, dtype=torch.bfloat16) * 0.05)(B, S, D)),
            "w1": _w((lambda *s: torch.randn(*s, dtype=torch.bfloat16) * 0.4)(S, F) * (S ** -0.5)),
            "b1": _w((lambda *s: torch.randn(*s, dtype=torch.bfloat16) * 3.2)(F) * 0.02),
            "w2": _w((lambda *s: torch.randn(*s, dtype=torch.bfloat16) * 0.2)(F, S) * (F ** -0.5)),
            "b2": _w((lambda *s: torch.randn(*s, dtype=torch.bfloat16) * 0.4)(S) * 0.02),
        }
    _B_in = _B_setup()

    return {
        "A_x": _A_in["x"],
        "A_w_r": _A_in["w_r"],
        "A_w_i": _A_in["w_i"],
        "B_x": _B_in["x"],
        "B_w1": _B_in["w1"],
        "B_b1": _B_in["b1"],
        "B_w2": _B_in["w2"],
        "B_b2": _B_in["b2"],
    }

def reference(A_x, A_w_r, A_w_i, B_x, B_w1, B_b1, B_w2, B_b2):
    def _A_ref(x, w_r, w_i):
        B, S, D = x.shape
        X = (lambda x, axes=(-2,-1): torch.fft.rfft2(x.float(), dim=axes))(x, axes=(-2, -1))
        W = w_r + 1j * w_i
        X = X * W
        y = (lambda x, s, axes=(-2,-1): torch.fft.irfft2(x, s=s, dim=axes).to(torch.bfloat16))(X, (S, D), axes=(-2, -1))
        return y

    def _B_ref(x, w1, b1, w2, b2):
        B, S, D = x.shape
        h = _layernorm(x, axis=-1)
        u = torch.einsum("bsd,sf->bdf", h, w1) + b1
        u = _gelu(u)
        y = torch.einsum("bdf,fs->bds", u, w2) + b2
        return (lambda x, *d: x.permute(*d))(y, 0, 2, 1)

    x = A_x
    h = x + _A_ref(_layernorm(x, axis=-1), A_w_r, A_w_i)
    h2 = h + _B_ref(_layernorm(h, axis=-1), B_w1, B_b1, B_w2, B_b2)
    return h2
```

```asm
; @launch grid=(256,1,1) block=(512,1,1) lds=163840
.amdgcn_target "amdgcn-amd-amdhsa--gfx950"
.text
.globl sequential_preLN__spectral_gfnet__mixer_token_mlp__prompt_kernel
.p2align 8
.type sequential_preLN__spectral_gfnet__mixer_token_mlp__prompt_kernel,@function
sequential_preLN__spectral_gfnet__mixer_token_mlp__prompt_kernel:
    s_cmp_ge_u32 s2, 256
    s_cbranch_scc1 Z_end
    v_and_b32 v8, 15, v0
    v_lshlrev_b32 v8, 2, v8
    v_add_u32 v8, 155648, v8
    v_mov_b32 v7, 0
    ds_write_b32 v8, v7
s_getpc_b64 s[68:69]
Z_pc0:
    s_add_u32 s68, s68, sequential_preLN__spectral_gfnet__mixer_token_mlp__prompt_kernel-Z_pc0
    s_addc_u32 s69, s69, -1
    s_mov_b32 s70, code_end-sequential_preLN__spectral_gfnet__mixer_token_mlp__prompt_kernel
    s_mov_b32 s71, 0x20000
    v_lshlrev_b32 v9, 4, v0
    s_movk_i32 s3, 0
    buffer_load_dwordx4 a[124:127], v9, s[68:71], s3 offen
    s_movk_i32 s3, 8192
    buffer_load_dwordx4 a[124:127], v9, s[68:71], s3 offen
    s_lshr_b32 s3, s2, 3
    s_lshl_b32 s3, s3, 9
    s_add_u32 s3, s3, 16384
    v_cmp_gt_u32 vcc, 32, v0
    s_nop 0
    s_and_b64 exec, exec, vcc
    s_cbranch_execz Z_nocw
    buffer_load_dwordx4 a[124:127], v9, s[68:71], s3 offen
Z_nocw:
    s_mov_b64 exec, -1
    s_waitcnt lgkmcnt(0)
    s_load_dwordx2 s[32:33], s[0:1], 0
    s_load_dwordx2 s[20:21], s[0:1], 80
    s_load_dwordx4 s[4:7], s[0:1], 8
    s_load_dwordx8 s[8:15], s[0:1], 32
    s_load_dwordx4 s[16:19], s[0:1], 64
    s_barrier
    v_lshrrev_b32 v7, 6, v0
    v_and_b32 v2, 63, v0
    v_and_b32 v10, 255, v0
    v_readfirstlane_b32 s72, v7
    v_lshlrev_b32 v3, 4, v2
    v_and_b32 v4, 3, v7
    v_lshlrev_b32 v9, 4, v10
    v_lshrrev_b32 v5, 4, v2
    v_and_b32 v6, 15, v2
    s_and_b32 s101, s2, 7
    s_lshr_b32 s100, s2, 3
    s_lshl_b32 s73, s101, 5
    s_add_u32 s73, s73, s100
    s_mov_b32 s34, 1835008
    s_mov_b32 s35, 0x20000
    s_mov_b32 s22, 6291456
    s_mov_b32 s23, 0x20000
    s_mov_b32 s26, 2097152
    s_mov_b32 s27, 0x20000
    s_mov_b32 s30, 1024
    s_mov_b32 s31, 0x20000
    s_mov_b32 s38, 1835008
    s_mov_b32 s39, 0x20000
    s_mov_b32 s42, 1835008
    s_mov_b32 s43, 0x20000
    s_mov_b32 s46, 1605632
    s_mov_b32 s47, 0x20000
    s_mov_b32 s50, 7340032
    s_mov_b32 s51, 0x20000
    s_mov_b32 s54, 7340032
    s_mov_b32 s55, 0x20000
    s_mov_b32 s58, 3584
    s_mov_b32 s59, 0x20000
    s_mov_b32 s62, 4096
    s_mov_b32 s63, 0x20000
    s_mov_b32 s66, 1835008
    s_mov_b32 s67, 0x20000
    v_lshrrev_b32 v7, 4, v10
    v_lshlrev_b32 v11, 16, v7
    v_lshl_add_u32 v11, v6, 4, v11
    v_mov_b32 v18, 155648
    v_mov_b32 v19, 1
    s_cmp_ge_u32 s72, 4
    s_cselect_b32 s3, -1, 0
    v_mov_b32 v20, 0
    v_mov_b32 v24, s3
    v_mov_b32 v21, 0
    v_mov_b32 v25, s3
    v_mov_b32 v22, 0
    v_mov_b32 v26, s3
    v_mov_b32 v23, 0
    v_mov_b32 v27, s3
    s_lshl_b32 s80, s72, 9
    s_add_u32 s80, s80, s73
    s_mul_i32 s80, s80, 896
    s_add_u32 s81, s80, 229376
    s_lshl_b32 s88, s73, 13
    s_cmp_ge_u32 s72, 4
    s_cbranch_scc1 Z_agent0
    s_mov_b32 exec_lo, 0xffffffff
    s_mov_b32 exec_hi, 0xffffff
    s_waitcnt lgkmcnt(0)
    buffer_load_dwordx4 v[20:23], v3, s[32:35], s80 offen
    buffer_load_dwordx4 v[24:27], v3, s[32:35], s81 offen
    s_mov_b64 exec, -1
    s_branch Z_fft
Z_agent0:
    s_add_u32 s92, s88, 4096
    s_add_u32 s93, s88, 4194304
    s_add_u32 s94, s88, 4198400
    s_add_u32 s95, s88, 2097152
    s_add_u32 s96, s88, 2101248
    s_lshr_b32 s90, s73, 6
    s_lshl_b32 s90, s90, 1
    s_and_b32 s3, s73, 15
    s_lshl_b32 s3, s3, 3
    s_add_u32 s90, s90, s3
    s_bfe_u32 s3, s73, 0x20004
    s_lshl_b32 s3, s3, 9
    s_add_u32 s90, s90, s3
    v_lshrrev_b32 v7, 5, v2
    v_add_u32 v7, s90, v7
    v_and_b32 v8, 31, v2
    v_lshlrev_b32 v8, 4, v8
    s_bfe_u32 s91, s72, 0x10001
    s_mul_i32 s3, s91, -2
    s_add_u32 s3, s3, 1
    v_add_u32 v12, 0, v7
    v_mul_i32_i24 v12, s3, v12
    v_and_b32 v12, 2047, v12
    v_mul_u32_u24 v12, 450, v12
    v_and_b32 v12, -16, v12
    v_add_u32 v12, v12, v8
    v_add_u32 v13, 128, v7
    v_mul_i32_i24 v13, s3, v13
    v_and_b32 v13, 2047, v13
    v_mul_u32_u24 v13, 450, v13
    v_and_b32 v13, -16, v13
    v_add_u32 v13, v13, v8
    v_add_u32 v14, 256, v7
    v_mul_i32_i24 v14, s3, v14
    v_and_b32 v14, 2047, v14
    v_mul_u32_u24 v14, 450, v14
    v_and_b32 v14, -16, v14
    v_add_u32 v14, v14, v8
    v_add_u32 v15, 384, v7
    v_mul_i32_i24 v15, s3, v15
    v_and_b32 v15, 2047, v15
    v_mul_u32_u24 v15, 450, v15
    v_and_b32 v15, -16, v15
    v_add_u32 v15, v15, v8
    s_and_b32 s3, s72, 3
    s_lshl_b32 s3, s3, 12
    s_mov_b32 s30, 921600
    s_bitcmp1_b32 s72, 0
    s_waitcnt lgkmcnt(0)
    s_cselect_b32 s28, s6, s4
    s_cselect_b32 s29, s7, s5
    buffer_store_dwordx4 v[20:23], v9, s[20:23], s88 offen sc1
    buffer_store_dwordx4 v[20:23], v9, s[20:23], s92 offen sc1
    buffer_store_dwordx4 v[24:27], v9, s[20:23], s95 offen sc1
    buffer_store_dwordx4 v[24:27], v9, s[20:23], s96 offen sc1
    s_add_u32 m0, s3, 49152
    s_nop 0
    buffer_load_dwordx4 v12, s[28:31], 0 offen  lds
    s_add_u32 m0, s3, 50176
    s_nop 0
    buffer_load_dwordx4 v13, s[28:31], 0 offen  lds
    s_add_u32 m0, s3, 51200
    s_nop 0
    buffer_load_dwordx4 v14, s[28:31], 0 offen  lds
    s_add_u32 m0, s3, 52224
    s_nop 0
    buffer_load_dwordx4 v15, s[28:31], 0 offen  lds
    s_mov_b32 s44, s18
    s_mov_b32 s45, s19
    s_mov_b32 s46, 256
    s_and_b32 s78, s2, 3
    s_lshl_b32 s78, s78, 6
    s_waitcnt vmcnt(4)
    s_mov_b64 exec, 1
    ds_add_rtn_u32 v7, v18, v19 offset:32
    s_waitcnt lgkmcnt(0)
    v_readfirstlane_b32 s3, v7
    s_nop 0
    s_cmp_lg_u32 s3, 3
    s_cselect_b32 s78, 0x10000000, s78
    buffer_atomic_add v19, v20, s[44:47], s78 offen sc1
    s_mov_b64 exec, -1
    s_mov_b32 s46, 1605632
    buffer_store_dwordx4 v[20:23], v9, s[20:23], s93 offen sc1
    buffer_store_dwordx4 v[20:23], v9, s[20:23], s94 offen sc1
    s_branch Z_agent
Z_fft:
    s_setprio 2
    s_getpc_b64 s[68:69]
    s_add_u32 s68, s68, tables@rel32@lo+4
    s_addc_u32 s69, s69, tables@rel32@hi+12
    s_mov_b32 s70, 12288
    s_mov_b32 s71, 0x20000
    s_mov_b32 s48, s8
    s_mov_b32 s49, s9
    s_mov_b32 s56, s10
    s_mov_b32 s57, s11
    s_mov_b32 s52, s12
    s_mov_b32 s53, s13
    s_mov_b32 s60, s14
    s_mov_b32 s61, s15
    s_mov_b32 s64, s16
    s_mov_b32 s65, s17
    s_mov_b32 s12, s18
    s_mov_b32 s13, s19
    s_mov_b32 s8, s6
    s_mov_b32 s9, s7
    s_mov_b32 s14, 256
    s_mov_b32 s15, 0x20000
    s_mov_b32 s10, 921600
    s_mov_b32 s11, 0x20000
    s_mov_b32 s6, 921600
    s_mov_b32 s7, 0x20000
    s_add_u32 s24, s20, 2097152
    s_addc_u32 s25, s21, 0
    s_add_u32 s36, s20, 7340032
    s_addc_u32 s37, s21, 0
    s_add_u32 s40, s20, 9437184
    s_addc_u32 s41, s21, 0
    s_add_u32 s44, s20, 11534336
    s_addc_u32 s45, s21, 0
    s_and_b32 s18, s72, 3
    s_lshl_b32 s19, s18, 1
    s_lshr_b32 s3, s72, 2
    s_add_u32 s19, s19, s3
    s_mul_i32 s3, s101, 28
    s_add_u32 s3, s3, s100
    s_mul_i32 s74, s3, 9363
    s_lshr_b32 s74, s74, 16
    s_mul_i32 s75, s74, 7
    s_sub_u32 s75, s3, s75
    s_cmp_lt_u32 s100, 28
    s_cselect_b32 s77, 1, 0
    s_cmp_lt_u32 s3, 196
    s_cselect_b32 s76, s77, 0
    s_mul_i32 s79, s73, 8192
    s_add_u32 s79, s79, 4194304
    s_lshl_b32 s82, s73, 8
    s_add_u32 s83, s82, 0x100000
    s_lshl_b32 s85, s72, 14
    s_add_u32 s85, s85, 16384
    s_lshl_b32 s3, s74, 7
    s_mul_i32 s86, s19, 114688
    s_add_u32 s86, s86, s3
    s_mul_i32 s87, s19, 917504
    s_add_u32 s87, s87, s3
    s_cmp_eq_u32 s76, 0
    s_cselect_b32 s86, 0x10000000, s86
    s_lshl_b32 s89, s100, 6
    s_add_u32 s89, s89, s18
    s_mul_i32 s89, s89, 3584
    s_lshl_b32 s3, s101, 9
    s_add_u32 s89, s89, s3
    s_cmp_eq_u32 s101, 7
    s_cselect_b32 s89, 0x10000000, s89
    s_movk_i32 s16, 0
    buffer_load_dwordx4 a[0:3], v3, s[68:71], s16 offen offset:0
    s_movk_i32 s16, 0
    buffer_load_dwordx4 a[4:7], v3, s[68:71], s16 offen offset:1024
    s_movk_i32 s16, 4096
    buffer_load_dwordx4 v[28:31], v3, s[68:71], s16 offen offset:0
    s_movk_i32 s16, 4096
    buffer_load_dwordx4 v[32:35], v3, s[68:71], s16 offen offset:1024
    s_movk_i32 s16, 0
    buffer_load_dwordx4 a[8:11], v3, s[68:71], s16 offen offset:2048
    s_movk_i32 s16, 0
    buffer_load_dwordx4 a[12:15], v3, s[68:71], s16 offen offset:3072
    v_and_b32 v72, 4, v2
    v_bfe_u32 v73, v2, 3, 1
    v_lshl_add_u32 v72, v73, 1, v72
    v_bfe_u32 v73, v2, 1, 1
    v_add_u32 v72, v72, v73
    v_lshrrev_b32 v74, 5, v2
    v_lshlrev_b32 v74, 2, v74
    v_lshl_add_u32 v73, v74, 8, s73
    v_mul_u32_u24 v73, v73, v72
    v_lshlrev_b32 v78, 8, v72
    v_cvt_f32_u32 v73, v73
    v_cvt_f32_u32 v78, v78
    v_mul_f32 v73, 0x3a000000, v73
    v_mul_f32 v78, 0x3a000000, v78
    v_and_b32 v75, 1, v2
    v_cvt_f32_u32 v75, v75
    v_mul_f32 v75, 0x3e800000, v75
    v_add_f32 v75, v75, v73
    v_mov_b32 v73, 0x3eb504f3
    v_fract_f32 v72, v75
    v_cos_f32 v76, v72
    v_sin_f32 v77, v72
    v_add_f32 v75, v75, v78
    v_mul_f32 v76, v76, v73
    v_mul_f32 v77, v77, v73
    v_cvt_pk_f16_f32 v68, v76, v77
    v_fract_f32 v72, v75
    v_cos_f32 v76, v72
    v_sin_f32 v77, v72
    v_add_f32 v75, v75, v78
    v_mul_f32 v76, v76, v73
    v_mul_f32 v77, v77, v73
    v_cvt_pk_f16_f32 v69, v76, v77
    v_fract_f32 v72, v75
    v_cos_f32 v76, v72
    v_sin_f32 v77, v72
    v_add_f32 v75, v75, v78
    v_mul_f32 v76, v76, v73
    v_mul_f32 v77, v77, v73
    v_cvt_pk_f16_f32 v70, v76, v77
    v_fract_f32 v72, v75
    v_cos_f32 v76, v72
    v_sin_f32 v77, v72
    v_mul_f32 v76, v76, v73
    v_mul_f32 v77, v77, v73
    v_cvt_pk_f16_f32 v71, v76, v77
    v_mov_b32 v66, 0x3b124925
    v_mov_b32 v67, 0x3727c5ac
    v_lshl_add_u32 v72, v4, 11, v3
    v_lshlrev_b32 v73, 3, v2
    v_lshl_add_u32 v73, v4, 11, v73
    v_lshlrev_b32 v7, 9, v5
    v_lshl_add_u32 v74, v6, 3, v7
    v_lshl_add_u32 v74, v4, 11, v74
    v_lshrrev_b32 v7, 5, v2
    v_and_b32 v75, 31, v2
    v_lshl_add_u32 v75, v4, 6, v75
    v_mul_u32_u24 v65, 8192, v75
    v_lshl_add_u32 v65, v7, 4, v65
    v_lshlrev_b32 v76, 5, v75
    v_lshl_add_u32 v76, v7, 4, v76
    v_lshlrev_b32 v75, 3, v75
    v_lshl_add_u32 v75, v7, 12, v75
    v_lshlrev_b32 v64, 5, v6
    v_lshl_add_u32 v64, v5, 3, v64
    s_lshl_b32 s90, s73, 5
    s_add_u32 s90, s90, 4194304
    s_add_u32 s91, s90, 262144
    s_waitcnt vmcnt(6)
    v_lshlrev_b32 v80, 16, v20
    v_and_b32 v81, 0xffff0000, v20
    v_lshlrev_b32 v82, 16, v21
    v_and_b32 v83, 0xffff0000, v21
    v_lshlrev_b32 v84, 16, v22
    v_and_b32 v85, 0xffff0000, v22
    v_lshlrev_b32 v86, 16, v23
    v_and_b32 v87, 0xffff0000, v23
    v_lshlrev_b32 v88, 16, v24
    v_and_b32 v89, 0xffff0000, v24
    v_lshlrev_b32 v90, 16, v25
    v_and_b32 v91, 0xffff0000, v25
    v_lshlrev_b32 v92, 16, v26
    v_and_b32 v93, 0xffff0000, v26
    v_lshlrev_b32 v94, 16, v27
    v_and_b32 v95, 0xffff0000, v27
    v_readfirstlane_b32 s92, v80
    v_readfirstlane_b32 s93, v88
    v_mov_b32 v96, 0
    v_mov_b32 v97, 0
    v_mov_b32 v100, 0
    v_mov_b32 v101, 0
    v_mov_b32 v98, 0
    v_mov_b32 v99, 0
    v_mov_b32 v102, 0
    v_mov_b32 v103, 0
    s_mov_b32 exec_lo, 0xffffffff
    s_mov_b32 exec_hi, 0xffffff
    v_pk_add_f32 v[104:105], v[80:81], s[92:93] op_sel:[0,0] op_sel_hi:[1,0] neg_lo:[0,1] neg_hi:[0,1]
    v_pk_fma_f32 v[96:97], v[104:105], v[104:105], v[96:97]
    v_pk_add_f32 v[100:101], v[100:101], v[104:105]
    v_pk_add_f32 v[106:107], v[88:89], s[92:93] op_sel:[0,1] op_sel_hi:[1,1] neg_lo:[0,1] neg_hi:[0,1]
    v_pk_fma_f32 v[98:99], v[106:107], v[106:107], v[98:99]
    v_pk_add_f32 v[102:103], v[102:103], v[106:107]
    v_pk_add_f32 v[108:109], v[82:83], s[92:93] op_sel:[0,0] op_sel_hi:[1,0] neg_lo:[0,1] neg_hi:[0,1]
    v_pk_fma_f32 v[96:97], v[108:109], v[108:109], v[96:97]
    v_pk_add_f32 v[100:101], v[100:101], v[108:109]
    v_pk_add_f32 v[110:111], v[90:91], s[92:93] op_sel:[0,1] op_sel_hi:[1,1] neg_lo:[0,1] neg_hi:[0,1]
    v_pk_fma_f32 v[98:99], v[110:111], v[110:111], v[98:99]
    v_pk_add_f32 v[102:103], v[102:103], v[110:111]
    v_pk_add_f32 v[104:105], v[84:85], s[92:93] op_sel:[0,0] op_sel_hi:[1,0] neg_lo:[0,1] neg_hi:[0,1]
    v_pk_fma_f32 v[96:97], v[104:105], v[104:105], v[96:97]
    v_pk_add_f32 v[100:101], v[100:101], v[104:105]
    v_pk_add_f32 v[106:107], v[92:93], s[92:93] op_sel:[0,1] op_sel_hi:[1,1] neg_lo:[0,1] neg_hi:[0,1]
    v_pk_fma_f32 v[98:99], v[106:107], v[106:107], v[98:99]
    v_pk_add_f32 v[102:103], v[102:103], v[106:107]
    v_pk_add_f32 v[108:109], v[86:87], s[92:93] op_sel:[0,0] op_sel_hi:[1,0] neg_lo:[0,1] neg_hi:[0,1]
    v_pk_fma_f32 v[96:97], v[108:109], v[108:109], v[96:97]
    v_pk_add_f32 v[100:101], v[100:101], v[108:109]
    v_pk_add_f32 v[110:111], v[94:95], s[92:93] op_sel:[0,1] op_sel_hi:[1,1] neg_lo:[0,1] neg_hi:[0,1]
    v_pk_fma_f32 v[98:99], v[110:111], v[110:111], v[98:99]
    v_pk_add_f32 v[102:103], v[102:103], v[110:111]
    s_mov_b64 exec, -1
    v_add_f32 v100, v100, v101
    v_add_f32 v96, v96, v97
    v_add_f32 v102, v102, v103
    v_add_f32 v98, v98, v99
    s_nop 0
    v_permlane32_swap_b32 v100, v102
    v_permlane32_swap_b32 v96, v98
    v_add_f32 v100, v100, v102
    v_add_f32 v96, v96, v98
    s_nop 1
    v_permlane16_swap_b32 v100, v96
    v_add_f32 v100, v100, v96
    s_nop 1
    v_add_f32_dpp v100, v100, v100 quad_perm:[1,0,3,2] row_mask:0xf bank_mask:0xf
    s_nop 1
    v_add_f32_dpp v100, v100, v100 quad_perm:[2,3,0,1] row_mask:0xf bank_mask:0xf
    s_nop 1
    v_add_f32_dpp v100, v100, v100 row_half_mirror row_mask:0xf bank_mask:0xf
    s_nop 1
    v_add_f32_dpp v100, v100, v100 row_mirror row_mask:0xf bank_mask:0xf
    s_nop 0
    v_readlane_b32 s94, v100, 0
    v_readlane_b32 s95, v100, 32
    v_readlane_b32 s96, v100, 16
    v_readlane_b32 s97, v100, 48
    v_pk_mul_f32 v[104:105], s[94:95], v[66:67] op_sel_hi:[1,0]
    s_nop 0
    v_pk_mul_f32 v[106:107], s[96:97], v[66:67] op_sel_hi:[1,0]
    v_pk_fma_f32 v[106:107], v[104:105], v[104:105], v[106:107] neg_lo:[1,0,0] neg_hi:[1,0,0]
    v_pk_add_f32 v[104:105], v[104:105], s[92:93]
    v_cvt_pk_bf16_f32 v110, v106, v107
    v_cvt_pk_bf16_f32 v111, v104, v105
    v_lshlrev_b32 v106, 16, v110
    v_and_b32 v107, 0xffff0000, v110
    v_lshlrev_b32 v108, 16, v111
    v_and_b32 v109, 0xffff0000, v111
    v_pk_add_f32 v[106:107], v[106:107], v[66:67] op_sel:[0,1] op_sel_hi:[1,1]
    v_cvt_pk_bf16_f32 v110, v106, v107
    v_lshlrev_b32 v106, 16, v110
    v_and_b32 v107, 0xffff0000, v110
    v_sqrt_f32 v106, v106
    v_sqrt_f32 v107, v107
    s_nop 0
    v_cvt_pk_bf16_f32 v110, v106, v107
    v_lshlrev_b32 v106, 16, v110
    v_and_b32 v107, 0xffff0000, v110
    v_rcp_f32 v106, v106
    v_rcp_f32 v107, v107
    s_mov_b32 exec_lo, 0xffffffff
    s_mov_b32 exec_hi, 0xffffff
    v_pk_add_f32 v[80:81], v[80:81], v[108:109] op_sel:[0,0] op_sel_hi:[1,0] neg_lo:[0,1] neg_hi:[0,1]
    v_pk_add_f32 v[88:89], v[88:89], v[108:109] op_sel:[0,1] op_sel_hi:[1,1] neg_lo:[0,1] neg_hi:[0,1]
    v_pk_add_f32 v[82:83], v[82:83], v[108:109] op_sel:[0,0] op_sel_hi:[1,0] neg_lo:[0,1] neg_hi:[0,1]
    v_pk_add_f32 v[90:91], v[90:91], v[108:109] op_sel:[0,1] op_sel_hi:[1,1] neg_lo:[0,1] neg_hi:[0,1]
    v_pk_add_f32 v[84:85], v[84:85], v[108:109] op_sel:[0,0] op_sel_hi:[1,0] neg_lo:[0,1] neg_hi:[0,1]
    v_pk_add_f32 v[92:93], v[92:93], v[108:109] op_sel:[0,1] op_sel_hi:[1,1] neg_lo:[0,1] neg_hi:[0,1]
    v_pk_add_f32 v[86:87], v[86:87], v[108:109] op_sel:[0,0] op_sel_hi:[1,0] neg_lo:[0,1] neg_hi:[0,1]
    v_pk_add_f32 v[94:95], v[94:95], v[108:109] op_sel:[0,1] op_sel_hi:[1,1] neg_lo:[0,1] neg_hi:[0,1]
    v_cvt_pk_bf16_f32 v81, v80, v81
    v_cvt_pk_bf16_f32 v89, v88, v89
    v_cvt_pk_bf16_f32 v83, v82, v83
    v_cvt_pk_bf16_f32 v91, v90, v91
    v_cvt_pk_bf16_f32 v85, v84, v85
    v_cvt_pk_bf16_f32 v93, v92, v93
    v_cvt_pk_bf16_f32 v87, v86, v87
    v_cvt_pk_bf16_f32 v95, v94, v95
    v_lshlrev_b32 v80, 16, v81
    v_and_b32 v81, 0xffff0000, v81
    v_lshlrev_b32 v88, 16, v89
    v_and_b32 v89, 0xffff0000, v89
    v_lshlrev_b32 v82, 16, v83
    v_and_b32 v83, 0xffff0000, v83
    v_lshlrev_b32 v90, 16, v91
    v_and_b32 v91, 0xffff0000, v91
    v_lshlrev_b32 v84, 16, v85
    v_and_b32 v85, 0xffff0000, v85
    v_lshlrev_b32 v92, 16, v93
    v_and_b32 v93, 0xffff0000, v93
    v_lshlrev_b32 v86, 16, v87
    v_and_b32 v87, 0xffff0000, v87
    v_lshlrev_b32 v94, 16, v95
    v_and_b32 v95, 0xffff0000, v95
    v_pk_mul_f32 v[80:81], v[80:81], v[106:107] op_sel:[0,0] op_sel_hi:[1,0]
    v_pk_mul_f32 v[88:89], v[88:89], v[106:107] op_sel:[0,1] op_sel_hi:[1,1]
    v_pk_mul_f32 v[82:83], v[82:83], v[106:107] op_sel:[0,0] op_sel_hi:[1,0]
    v_pk_mul_f32 v[90:91], v[90:91], v[106:107] op_sel:[0,1] op_sel_hi:[1,1]
    v_pk_mul_f32 v[84:85], v[84:85], v[106:107] op_sel:[0,0] op_sel_hi:[1,0]
    v_pk_mul_f32 v[92:93], v[92:93], v[106:107] op_sel:[0,1] op_sel_hi:[1,1]
    v_pk_mul_f32 v[86:87], v[86:87], v[106:107] op_sel:[0,0] op_sel_hi:[1,0]
    v_pk_mul_f32 v[94:95], v[94:95], v[106:107] op_sel:[0,1] op_sel_hi:[1,1]
    s_mov_b64 exec, -1
    v_cvt_pk_bf16_f32 v81, v80, v81
    v_cvt_pk_bf16_f32 v83, v82, v83
    v_cvt_pk_bf16_f32 v85, v84, v85
    v_cvt_pk_bf16_f32 v87, v86, v87
    v_lshlrev_b32 v80, 16, v81
    v_and_b32 v81, 0xffff0000, v81
    v_lshlrev_b32 v82, 16, v83
    v_and_b32 v83, 0xffff0000, v83
    v_lshlrev_b32 v84, 16, v85
    v_and_b32 v85, 0xffff0000, v85
    v_lshlrev_b32 v86, 16, v87
    v_and_b32 v87, 0xffff0000, v87
    v_cvt_pk_f16_f32 v20, v80, v81
    v_cvt_pk_f16_f32 v21, v82, v83
    v_cvt_pk_f16_f32 v22, v84, v85
    v_cvt_pk_f16_f32 v23, v86, v87
    ds_write_b128 v72, v[20:23] offset:0
    v_cvt_pk_bf16_f32 v89, v88, v89
    v_cvt_pk_bf16_f32 v91, v90, v91
    v_cvt_pk_bf16_f32 v93, v92, v93
    v_cvt_pk_bf16_f32 v95, v94, v95
    v_lshlrev_b32 v88, 16, v89
    v_and_b32 v89, 0xffff0000, v89
    v_lshlrev_b32 v90, 16, v91
    v_and_b32 v91, 0xffff0000, v91
    v_lshlrev_b32 v92, 16, v93
    v_and_b32 v93, 0xffff0000, v93
    v_lshlrev_b32 v94, 16, v95
    v_and_b32 v95, 0xffff0000, v95
    v_cvt_pk_f16_f32 v24, v88, v89
    v_cvt_pk_f16_f32 v25, v90, v91
    v_cvt_pk_f16_f32 v26, v92, v93
    v_cvt_pk_f16_f32 v27, v94, v95
    ds_write_b128 v72, v[24:27] offset:1024
    s_waitcnt lgkmcnt(0)
    ds_read_b64_tr_b16 v[20:21], v73 offset:0
    ds_read_b64_tr_b16 v[22:23], v73 offset:512
    ds_read_b64_tr_b16 v[24:25], v73 offset:1024
    ds_read_b64_tr_b16 v[26:27], v73 offset:1536
    s_waitcnt vmcnt(0)
    s_waitcnt lgkmcnt(2)
    v_mfma_f32_16x16x32_f16 v[80:83], v[20:23], a[0:3], 0
    v_mfma_f32_16x16x32_f16 v[84:87], v[20:23], a[4:7], 0
    s_waitcnt lgkmcnt(0)
    v_mfma_f32_16x16x32_f16 v[88:91], v[24:27], a[0:3], 0
    v_mfma_f32_16x16x32_f16 v[92:95], v[24:27], a[4:7], 0
    s_nop 3
    v_pk_mul_f32 v[96:97], v[80:81], v[28:29]
    v_pk_mul_f32 v[104:105], v[84:85], v[28:29]
    v_pk_mul_f32 v[98:99], v[82:83], v[30:31]
    v_pk_mul_f32 v[106:107], v[86:87], v[30:31]
    v_pk_fma_f32 v[96:97], v[84:85], v[32:33], v[96:97]
    v_pk_fma_f32 v[104:105], v[80:81], v[32:33], v[104:105] neg_lo:[1,0,0] neg_hi:[1,0,0]
    v_pk_fma_f32 v[98:99], v[86:87], v[34:35], v[98:99]
    v_pk_fma_f32 v[106:107], v[82:83], v[34:35], v[106:107] neg_lo:[1,0,0] neg_hi:[1,0,0]
    v_cvt_pk_f16_f32 v20, v96, v104
    v_cvt_pk_f16_f32 v21, v97, v105
    v_cvt_pk_f16_f32 v22, v98, v106
    v_cvt_pk_f16_f32 v23, v99, v107
    s_nop 1
    v_mfma_f32_16x16x32_f16 v[80:83], v[20:23], a[8:11], 0
    v_mfma_f32_16x16x32_f16 v[84:87], v[20:23], a[12:15], 0
    v_pk_mul_f32 v[100:101], v[88:89], v[28:29]
    v_pk_mul_f32 v[108:109], v[92:93], v[28:29]
    v_pk_mul_f32 v[102:103], v[90:91], v[30:31]
    v_pk_mul_f32 v[110:111], v[94:95], v[30:31]
    v_pk_fma_f32 v[100:101], v[92:93], v[32:33], v[100:101]
    v_pk_fma_f32 v[108:109], v[88:89], v[32:33], v[108:109] neg_lo:[1,0,0] neg_hi:[1,0,0]
    v_pk_fma_f32 v[102:103], v[94:95], v[34:35], v[102:103]
    v_pk_fma_f32 v[110:111], v[90:91], v[34:35], v[110:111] neg_lo:[1,0,0] neg_hi:[1,0,0]
    v_cvt_pk_f16_f32 v24, v100, v108
    v_cvt_pk_f16_f32 v25, v101, v109
    v_cvt_pk_f16_f32 v26, v102, v110
    v_cvt_pk_f16_f32 v27, v103, v111
    s_nop 1
    v_mfma_f32_16x16x32_f16 v[88:91], v[24:27], a[8:11], 0
    v_mfma_f32_16x16x32_f16 v[92:95], v[24:27], a[12:15], 0
    v_cvt_pk_f16_f32 v112, v80, v84
    v_cvt_pk_f16_f32 v114, v81, v85
    v_cvt_pk_f16_f32 v116, v82, v86
    v_cvt_pk_f16_f32 v118, v83, v87
    s_nop 3
    v_cvt_pk_f16_f32 v113, v88, v92
    v_cvt_pk_f16_f32 v115, v89, v93
    v_cvt_pk_f16_f32 v117, v90, v94
    v_cvt_pk_f16_f32 v119, v91, v95
    ds_write_b64 v74, v[112:113] offset:8192
    ds_write_b64 v74, v[114:115] offset:8320
    ds_write_b64 v74, v[116:117] offset:8448
    ds_write_b64 v74, v[118:119] offset:8576
    v_add_u32 v8, 256, v75
    s_mov_b64 exec, 1
    ds_add_rtn_u32 v7, v18, v19 offset:4
    s_mov_b64 exec, -1
    s_mov_b32 s16, 0
    s_waitcnt lgkmcnt(0)
    v_readfirstlane_b32 s3, v7
    s_nop 0
    s_cmp_ge_u32 s3, 7
    s_cbranch_scc1 LB_done0
LB_spin0:
    ds_read_b32 v7, v18 offset:4
    s_add_u32 s16, s16, 1
    s_waitcnt lgkmcnt(0)
    v_readfirstlane_b32 s3, v7
    s_cmp_ge_u32 s16, 33554432
    s_cbranch_scc1 LB_done0
    s_cmp_lt_u32 s3, 8
    s_cbranch_scc1 LB_spin0
LB_done0:
    v_lshlrev_b32 v7, 2, v6
    ds_read_b32 v52, v7 offset:16384
    ds_read2st64_b64 v[20:23], v75 offset0:16 offset1:20
    ds_read2st64_b64 v[24:27], v8 offset0:16 offset1:20
    s_waitcnt lgkmcnt(1)
    v_mfma_f32_32x32x16_f16 v[96:111], v[68:71], v[20:23], 0
    s_waitcnt lgkmcnt(0)
    v_mfma_f32_32x32x16_f16 v[112:127], v[68:71], v[24:27], 0
    v_max_u32_dpp v52, v52, v52 quad_perm:[1,0,3,2] row_mask:0xf bank_mask:0xf
    s_nop 1
    v_max_u32_dpp v52, v52, v52 quad_perm:[2,3,0,1] row_mask:0xf bank_mask:0xf
    s_nop 1
    v_max_u32_dpp v52, v52, v52 row_half_mirror row_mask:0xf bank_mask:0xf
    s_nop 1
    v_max_u32_dpp v52, v52, v52 row_mirror row_mask:0xf bank_mask:0xf
    v_lshrrev_b32 v7, 5, v2
    v_lshl_add_u32 v7, v7, 2, 7
    v_lshrrev_b32 v52, v7, v52
    s_mov_b32 s3, 0xfffeffff
    s_mov_b32 s16, 0xfffefffe
    v_bfe_u32 v80, v52, 0, 1
    v_lshlrev_b32 v80, 16, v80
    v_bfe_u32 v81, v52, 1, 1
    v_lshlrev_b32 v81, 16, v81
    v_bfe_u32 v82, v52, 2, 1
    v_lshlrev_b32 v82, 16, v82
    v_bfe_u32 v83, v52, 3, 1
    v_lshlrev_b32 v83, 16, v83
    v_or_b32 v80, 1, v80
    v_or_b32 v83, 1, v83
    v_cvt_pk_f16_f32 v20, v96, v97
    v_cvt_pk_f16_f32 v21, v98, v99
    v_cvt_pk_f16_f32 v22, v100, v101
    v_cvt_pk_f16_f32 v23, v102, v103
    v_and_or_b32 v20, v20, s3, v80
    v_and_or_b32 v21, v21, s3, v81
    v_and_or_b32 v22, v22, s3, v82
    v_and_or_b32 v23, v23, s3, v83
    buffer_store_dwordx4 v[20:23], v76, s[20:23], s88 offen offset:0 sc1
    v_cvt_pk_f16_f32 v24, v112, v113
    v_cvt_pk_f16_f32 v25, v114, v115
    v_cvt_pk_f16_f32 v26, v116, v117
    v_cvt_pk_f16_f32 v27, v118, v119
    v_and_or_b32 v24, v24, s3, v80
    v_and_or_b32 v25, v25, s3, v81
    v_and_or_b32 v26, v26, s3, v82
    v_and_or_b32 v27, v27, s3, v83
    buffer_store_dwordx4 v[24:27], v76, s[20:23], s88 offen offset:1024 sc1
    s_mov_b64 exec, 1
    ds_add_u32 v18, v19 offset:40
    s_mov_b64 exec, -1
    v_lshlrev_b32 v7, 11, v5
    v_lshl_add_u32 v72, v6, 5, v7
    v_lshl_add_u32 v72, v4, 3, v72
    v_add_u32 v72, 147456, v72
    v_lshrrev_b32 v7, 1, v10
    v_lshlrev_b32 v74, 13, v7
    v_and_b32 v8, 1, v10
    v_lshl_add_u32 v74, v8, 4, v74
    v_lshlrev_b32 v75, 9, v5
    v_lshl_add_u32 v75, v6, 3, v75
    v_lshl_add_u32 v75, v4, 11, v75
    v_lshlrev_b32 v76, 12, v8
    v_lshl_add_u32 v76, v7, 3, v76
    v_lshlrev_b32 v73, 5, v10
    v_add_u32 v73, 32768, v73
    v_mov_b32 v60, 0
    v_mov_b32 v61, 0
    v_mov_b32 v62, 0
    v_mov_b32 v63, 0
    s_movk_i32 s16, 8192
    buffer_load_dwordx4 v[36:39], v3, s[68:71], s16 offen offset:2048
    s_movk_i32 s16, 8192
    buffer_load_dwordx4 v[40:43], v3, s[68:71], s16 offen offset:3072
    s_movk_i32 s16, 4096
    buffer_load_dwordx4 a[16:19], v3, s[68:71], s16 offen offset:2048
    s_movk_i32 s16, 4096
    buffer_load_dwordx4 a[20:23], v3, s[68:71], s16 offen offset:3072
    s_movk_i32 s16, 8192
    buffer_load_dwordx4 a[24:27], v3, s[68:71], s16 offen offset:0
    s_movk_i32 s16, 8192
    buffer_load_dwordx4 a[28:31], v3, s[68:71], s16 offen offset:1024
    buffer_load_dwordx2 v[56:57], v64, s[32:35], s80 offen
    buffer_load_dwordx2 v[58:59], v64, s[32:35], s81 offen
    s_mov_b32 exec_lo, 0xfff0fff
    s_mov_b32 exec_hi, 0xfff0fff
    buffer_load_dwordx2 v[60:61], v64, s[32:35], s80 offen offset:512
    buffer_load_dwordx2 v[62:63], v64, s[32:35], s81 offen offset:512
    s_mov_b64 exec, -1
    v_bfe_u32 v7, v2, 4, 2
    v_lshlrev_b32 v7, 1, v7
    v_and_b32 v8, 7, v2
    v_xor_b32 v7, v7, v8
    v_lshlrev_b32 v12, 4, v7
    v_lshrrev_b32 v7, 3, v2
    v_lshl_add_u32 v13, v7, 12, v12
    v_bfe_u32 v7, v2, 3, 2
    v_lshlrev_b32 v7, 8, v7
    v_lshrrev_b32 v8, 5, v2
    v_add_u32 v7, v7, v8
    v_mul_u32_u24 v7, 3584, v7
    v_add_u32 v12, v12, v7
    v_lshrrev_b32 v7, 2, v2
    v_lshlrev_b32 v14, 7, v7
    v_bfe_u32 v8, v2, 3, 2
    v_lshlrev_b32 v8, 5, v8
    v_add_u32 v14, v14, v8
    v_and_b32 v8, 3, v2
    v_lshl_add_u32 v14, v8, 3, v14
    v_add_u32 v14, s85, v14
    v_xor_b32 v15, 32, v14
    v_xor_b32 v16, 64, v14
    v_xor_b32 v17, 96, v14
    v_add_u32 v96, 147456, v9
    s_mov_b32 s16, 0
LB_spin1:
    ds_read_b32 v7, v18 offset:8
    s_add_u32 s16, s16, 1
    s_waitcnt lgkmcnt(0)
    v_readfirstlane_b32 s3, v7
    s_cmp_ge_u32 s16, 33554432
    s_cbranch_scc1 LB_done1
    s_cmp_lt_u32 s3, 1
    s_cbranch_scc1 LB_spin1
LB_done1:
    s_lshl_b32 s78, s73, 5
    s_add_u32 s7, s78, 0x100000
    s_lshl_b32 s17, s18, 10
    s_mov_b32 s6, 0
Z_pollT1:
    s_add_u32 m0, s17, 147456
    s_add_u32 s6, s6, 1
    buffer_load_dwordx4 v74, s[20:23], s78 offen sc1 lds
    s_add_u32 m0, s17, 151552
    s_nop 0
    buffer_load_dwordx4 v74, s[20:23], s7 offen sc1 lds
    s_waitcnt vmcnt(0)
    ds_read2_b32 v[98:99], v96 offset0:0 offset1:3
    ds_read_b32 v100, v96 offset:4096
    ds_read_b32 v101, v96 offset:4108
    s_waitcnt lgkmcnt(0)
    v_and_b32 v7, v98, v99
    v_and_b32 v100, v100, v101
    v_and_b32 v7, v7, v100
    v_and_b32 v7, 1, v7
    v_cmp_eq_u32 vcc, 0, v7
    s_cmp_ge_u32 s6, 1048576
    s_cbranch_scc1 Z_pollT1_done
    s_and_b64 exec, exec, vcc
    s_cbranch_execnz Z_pollT1
Z_pollT1_done:
    s_mov_b64 exec, -1
    ds_read_b128 v[112:115], v96
    ds_read_b128 v[116:119], v96 offset:4096
    v_and_b32 v8, 1, v10
    v_lshlrev_b32 v8, 2, v8
    s_waitcnt lgkmcnt(0)
    v_bfe_u32 v112, v112, 16, 1
    v_bfe_u32 v113, v113, 16, 1
    v_lshl_or_b32 v112, v113, 1, v112
    v_bfe_u32 v114, v114, 16, 1
    v_lshl_or_b32 v112, v114, 2, v112
    v_bfe_u32 v115, v115, 16, 1
    v_lshl_or_b32 v112, v115, 3, v112
    v_lshlrev_b32 v112, v8, v112
    v_bfe_u32 v116, v116, 16, 1
    v_bfe_u32 v117, v117, 16, 1
    v_lshl_or_b32 v116, v117, 1, v116
    v_bfe_u32 v118, v118, 16, 1
    v_lshl_or_b32 v116, v118, 2, v116
    v_bfe_u32 v119, v119, 16, 1
    v_lshl_or_b32 v116, v119, 3, v116
    v_lshlrev_b32 v116, v8, v116
    v_or_b32_dpp v112, v112, v112 quad_perm:[1,0,3,2] row_mask:0xf bank_mask:0xf
    s_nop 0
    v_or_b32_dpp v116, v116, v116 quad_perm:[1,0,3,2] row_mask:0xf bank_mask:0xf
    v_max_u32 v52, v112, v116
    s_nop 1
    v_max_u32_dpp v52, v52, v52 quad_perm:[2,3,0,1] row_mask:0xf bank_mask:0xf
    s_nop 1
    v_max_u32_dpp v52, v52, v52 row_half_mirror row_mask:0xf bank_mask:0xf
    s_nop 1
    v_max_u32_dpp v52, v52, v52 row_mirror row_mask:0xf bank_mask:0xf
    v_lshrrev_b32 v8, 4, v10
    v_lshl_add_u32 v8, v8, 2, v18
    ds_write_b32 v8, v52 offset:64
    v_add_u32 v8, 1024, v72
    s_mov_b64 exec, 1
    ds_add_rtn_u32 v7, v18, v19 offset:16
    s_mov_b64 exec, -1
    s_mov_b32 s16, 0
    s_waitcnt lgkmcnt(0)
    v_readfirstlane_b32 s3, v7
    s_nop 0
    s_cmp_ge_u32 s3, 3
    s_cbranch_scc1 LB_done2
LB_spin2:
    ds_read_b32 v7, v18 offset:16
    s_add_u32 s16, s16, 1
    s_waitcnt lgkmcnt(0)
    v_readfirstlane_b32 s3, v7
    s_cmp_ge_u32 s16, 33554432
    s_cbranch_scc1 LB_done2
    s_cmp_lt_u32 s3, 4
    s_cbranch_scc1 LB_spin2
LB_done2:
    ds_read2_b32 v[20:21], v72 offset0:0 offset1:128
    ds_read2_b32 v[22:23], v8 offset0:0 offset1:128
    ds_read2_b32 v[24:25], v72 offset0:1 offset1:129
    ds_read2_b32 v[26:27], v8 offset0:1 offset1:129
    s_waitcnt lgkmcnt(2)
    v_mfma_f32_16x16x32_f16 v[80:83], v[20:23], a[8:11], 0
    v_mfma_f32_16x16x32_f16 v[88:91], v[20:23], a[12:15], 0
    s_waitcnt lgkmcnt(0)
    v_mfma_f32_16x16x32_f16 v[84:87], v[24:27], a[8:11], 0
    v_mfma_f32_16x16x32_f16 v[92:95], v[24:27], a[12:15], 0
    s_nop 3
    v_pk_mul_f32 v[96:97], v[80:81], v[36:37]
    v_pk_mul_f32 v[104:105], v[88:89], v[36:37]
    v_pk_mul_f32 v[98:99], v[82:83], v[38:39]
    v_pk_mul_f32 v[106:107], v[90:91], v[38:39]
    v_pk_fma_f32 v[96:97], v[88:89], v[40:41], v[96:97]
    v_pk_fma_f32 v[104:105], v[80:81], v[40:41], v[104:105] neg_lo:[1,0,0] neg_hi:[1,0,0]
    v_pk_fma_f32 v[98:99], v[90:91], v[42:43], v[98:99]
    v_pk_fma_f32 v[106:107], v[82:83], v[42:43], v[106:107] neg_lo:[1,0,0] neg_hi:[1,0,0]
    v_cvt_pk_f16_f32 v20, v96, v104
    v_cvt_pk_f16_f32 v21, v97, v105
    v_cvt_pk_f16_f32 v22, v98, v106
    v_cvt_pk_f16_f32 v23, v99, v107
    s_nop 1
    v_mfma_f32_16x16x32_f16 v[80:83], a[8:11], v[20:23], 0
    v_mfma_f32_16x16x32_f16 v[88:91], a[12:15], v[20:23], 0
    v_pk_mul_f32 v[100:101], v[84:85], v[36:37]
    v_pk_mul_f32 v[108:109], v[92:93], v[36:37]
    v_pk_mul_f32 v[102:103], v[86:87], v[38:39]
    v_pk_mul_f32 v[110:111], v[94:95], v[38:39]
    v_pk_fma_f32 v[100:101], v[92:93], v[40:41], v[100:101]
    v_pk_fma_f32 v[108:109], v[84:85], v[40:41], v[108:109] neg_lo:[1,0,0] neg_hi:[1,0,0]
    v_pk_fma_f32 v[102:103], v[94:95], v[42:43], v[102:103]
    v_pk_fma_f32 v[110:111], v[86:87], v[42:43], v[110:111] neg_lo:[1,0,0] neg_hi:[1,0,0]
    v_cvt_pk_f16_f32 v24, v100, v108
    v_cvt_pk_f16_f32 v25, v101, v109
    v_cvt_pk_f16_f32 v26, v102, v110
    v_cvt_pk_f16_f32 v27, v103, v111
    s_nop 1
    v_mfma_f32_16x16x32_f16 v[84:87], a[8:11], v[24:27], 0
    v_mfma_f32_16x16x32_f16 v[92:95], a[12:15], v[24:27], 0
    s_mov_b32 s16, 0
LB_spin3:
    ds_read_b32 v7, v18 offset:12
    s_add_u32 s16, s16, 1
    s_waitcnt lgkmcnt(0)
    v_readfirstlane_b32 s3, v7
    s_cmp_ge_u32 s16, 33554432
    s_cbranch_scc1 LB_done3
    s_cmp_lt_u32 s3, 4
    s_cbranch_scc1 LB_spin3
LB_done3:
    v_lshl_add_u32 v7, v6, 2, v18
    ds_read_b32 v52, v7 offset:64
    ds_read_b128 v[44:47], v73
    ds_read_b128 v[48:51], v73 offset:16
    s_waitcnt lgkmcnt(2)
    v_max_u32_dpp v52, v52, v52 quad_perm:[1,0,3,2] row_mask:0xf bank_mask:0xf
    s_nop 1
    v_max_u32_dpp v52, v52, v52 quad_perm:[2,3,0,1] row_mask:0xf bank_mask:0xf
    s_nop 1
    v_max_u32_dpp v52, v52, v52 row_half_mirror row_mask:0xf bank_mask:0xf
    s_nop 1
    v_max_u32_dpp v52, v52, v52 row_mirror row_mask:0xf bank_mask:0xf
    v_max_u32 v52, 1, v52
    v_min_u32 v52, 253, v52
    v_lshlrev_b32 v54, 23, v52
    v_sub_u32 v52, 0x7f000000, v54
    s_waitcnt lgkmcnt(0)
    v_lshlrev_b32 v112, 16, v44
    v_and_b32 v120, 0xffff0000, v44
    v_lshlrev_b32 v113, 16, v45
    v_and_b32 v121, 0xffff0000, v45
    v_lshlrev_b32 v114, 16, v46
    v_and_b32 v122, 0xffff0000, v46
    v_lshlrev_b32 v115, 16, v47
    v_and_b32 v123, 0xffff0000, v47
    v_pk_mul_f32 v[112:113], v[112:113], v[52:53] op_sel_hi:[1,0]
    v_pk_mul_f32 v[120:121], v[120:121], v[52:53] op_sel_hi:[1,0]
    v_pk_mul_f32 v[114:115], v[114:115], v[52:53] op_sel_hi:[1,0]
    v_pk_mul_f32 v[122:123], v[122:123], v[52:53] op_sel_hi:[1,0]
    v_lshlrev_b32 v116, 16, v48
    v_and_b32 v124, 0xffff0000, v48
    v_lshlrev_b32 v117, 16, v49
    v_and_b32 v125, 0xffff0000, v49
    v_lshlrev_b32 v118, 16, v50
    v_and_b32 v126, 0xffff0000, v50
    v_lshlrev_b32 v119, 16, v51
    v_and_b32 v127, 0xffff0000, v51
    v_pk_mul_f32 v[116:117], v[116:117], v[52:53] op_sel_hi:[1,0]
    v_pk_mul_f32 v[124:125], v[124:125], v[52:53] op_sel_hi:[1,0]
    v_pk_mul_f32 v[118:119], v[118:119], v[52:53] op_sel_hi:[1,0]
    v_pk_mul_f32 v[126:127], v[126:127], v[52:53] op_sel_hi:[1,0]
    v_pk_mul_f32 v[96:97], v[80:81], v[112:113]
    v_pk_mul_f32 v[104:105], v[88:89], v[112:113]
    v_pk_mul_f32 v[98:99], v[82:83], v[114:115]
    v_pk_mul_f32 v[106:107], v[90:91], v[114:115]
    v_pk_fma_f32 v[96:97], v[88:89], v[120:121], v[96:97] neg_lo:[1,0,0] neg_hi:[1,0,0]
    v_pk_fma_f32 v[104:105], v[80:81], v[120:121], v[104:105]
    v_pk_fma_f32 v[98:99], v[90:91], v[122:123], v[98:99] neg_lo:[1,0,0] neg_hi:[1,0,0]
    v_pk_fma_f32 v[106:107], v[82:83], v[122:123], v[106:107]
    v_cvt_pk_f16_f32 v20, v96, v104
    v_cvt_pk_f16_f32 v21, v97, v105
    v_cvt_pk_f16_f32 v22, v98, v106
    v_cvt_pk_f16_f32 v23, v99, v107
    s_nop 1
    v_mfma_f32_16x16x32_f16 v[80:83], v[20:23], a[16:19], 0
    v_mfma_f32_16x16x32_f16 v[88:91], v[20:23], a[20:23], 0
    v_pk_mul_f32 v[100:101], v[84:85], v[116:117]
    v_pk_mul_f32 v[108:109], v[92:93], v[116:117]
    v_pk_mul_f32 v[102:103], v[86:87], v[118:119]
    v_pk_mul_f32 v[110:111], v[94:95], v[118:119]
    v_pk_fma_f32 v[100:101], v[92:93], v[124:125], v[100:101] neg_lo:[1,0,0] neg_hi:[1,0,0]
    v_pk_fma_f32 v[108:109], v[84:85], v[124:125], v[108:109]
    v_pk_fma_f32 v[102:103], v[94:95], v[126:127], v[102:103] neg_lo:[1,0,0] neg_hi:[1,0,0]
    v_pk_fma_f32 v[110:111], v[86:87], v[126:127], v[110:111]
    v_cvt_pk_f16_f32 v24, v100, v108
    v_cvt_pk_f16_f32 v25, v101, v109
    v_cvt_pk_f16_f32 v26, v102, v110
    v_cvt_pk_f16_f32 v27, v103, v111
    s_nop 1
    v_mfma_f32_16x16x32_f16 v[84:87], v[24:27], a[16:19], 0
    v_mfma_f32_16x16x32_f16 v[92:95], v[24:27], a[20:23], 0
    v_pk_mul_f32 v[96:97], v[80:81], v[36:37]
    v_pk_mul_f32 v[104:105], v[88:89], v[36:37]
    v_pk_mul_f32 v[98:99], v[82:83], v[38:39]
    v_pk_mul_f32 v[106:107], v[90:91], v[38:39]
    v_pk_fma_f32 v[96:97], v[88:89], v[40:41], v[96:97] neg_lo:[1,0,0] neg_hi:[1,0,0]
    v_pk_fma_f32 v[104:105], v[80:81], v[40:41], v[104:105]
    v_pk_fma_f32 v[98:99], v[90:91], v[42:43], v[98:99] neg_lo:[1,0,0] neg_hi:[1,0,0]
    v_pk_fma_f32 v[106:107], v[82:83], v[42:43], v[106:107]
    v_cvt_pk_f16_f32 v20, v96, v104
    v_cvt_pk_f16_f32 v21, v97, v105
    v_cvt_pk_f16_f32 v22, v98, v106
    v_cvt_pk_f16_f32 v23, v99, v107
    s_nop 1
    v_mfma_f32_16x16x32_f16 v[80:83], a[16:19], v[20:23], 0
    v_mfma_f32_16x16x32_f16 v[88:91], a[20:23], v[20:23], 0
    v_pk_mul_f32 v[100:101], v[84:85], v[36:37]
    v_pk_mul_f32 v[108:109], v[92:93], v[36:37]
    v_pk_mul_f32 v[102:103], v[86:87], v[38:39]
    v_pk_mul_f32 v[110:111], v[94:95], v[38:39]
    v_pk_fma_f32 v[100:101], v[92:93], v[40:41], v[100:101] neg_lo:[1,0,0] neg_hi:[1,0,0]
    v_pk_fma_f32 v[108:109], v[84:85], v[40:41], v[108:109]
    v_pk_fma_f32 v[102:103], v[94:95], v[42:43], v[102:103] neg_lo:[1,0,0] neg_hi:[1,0,0]
    v_pk_fma_f32 v[110:111], v[86:87], v[42:43], v[110:111]
    v_cvt_pk_f16_f32 v24, v100, v108
    v_cvt_pk_f16_f32 v25, v101, v109
    v_cvt_pk_f16_f32 v26, v102, v110
    v_cvt_pk_f16_f32 v27, v103, v111
    s_nop 1
    v_mfma_f32_16x16x32_f16 v[84:87], a[16:19], v[24:27], 0
    v_mfma_f32_16x16x32_f16 v[92:95], a[20:23], v[24:27], 0
    v_cvt_pk_f16_f32 v44, v80, v88
    v_cvt_pk_f16_f32 v46, v81, v89
    v_cvt_pk_f16_f32 v48, v82, v90
    v_cvt_pk_f16_f32 v50, v83, v91
    s_nop 3
    v_cvt_pk_f16_f32 v45, v84, v92
    v_cvt_pk_f16_f32 v47, v85, v93
    v_cvt_pk_f16_f32 v49, v86, v94
    v_cvt_pk_f16_f32 v51, v87, v95
    ds_write_b64 v75, v[44:45] offset:8192
    ds_write_b64 v75, v[46:47] offset:8320
    ds_write_b64 v75, v[48:49] offset:8448
    ds_write_b64 v75, v[50:51] offset:8576
    s_mov_b64 exec, 1
    ds_add_rtn_u32 v7, v18, v19 offset:20
    s_mov_b64 exec, -1
    s_mov_b32 s16, 0
    s_waitcnt lgkmcnt(0)
    v_readfirstlane_b32 s3, v7
    s_nop 0
    s_cmp_ge_u32 s3, 7
    s_cbranch_scc1 LB_done4
LB_spin4:
    ds_read_b32 v7, v18 offset:20
    s_add_u32 s16, s16, 1
    s_waitcnt lgkmcnt(0)
    v_readfirstlane_b32 s3, v7
    s_cmp_ge_u32 s16, 33554432
    s_cbranch_scc1 LB_done4
    s_cmp_lt_u32 s3, 8
    s_cbranch_scc1 LB_spin4
LB_done4:
    s_add_u32 s3, s79, 4096
    ds_read2st64_b64 v[96:99], v76 offset0:16 offset1:20
    ds_read2st64_b64 v[100:103], v76 offset0:18 offset1:22
    s_waitcnt lgkmcnt(1)
    v_or_b32 v96, 1, v96
    v_or_b32 v99, 1, v99
    buffer_store_dwordx4 v[96:99], v9, s[20:23], s79 offen sc1
    s_waitcnt lgkmcnt(0)
    v_or_b32 v100, 1, v100
    v_or_b32 v103, 1, v103
    buffer_store_dwordx4 v[100:103], v9, s[20:23], s3 offen sc1
    s_mov_b64 exec, 1
    ds_add_u32 v18, v19 offset:44
    s_mov_b64 exec, -1
    v_and_b32 v72, 4, v2
    v_bfe_u32 v73, v2, 3, 1
    v_lshl_add_u32 v72, v73, 1, v72
    v_bfe_u32 v73, v2, 1, 1
    v_add_u32 v72, v72, v73
    v_lshrrev_b32 v74, 5, v2
    v_lshlrev_b32 v74, 2, v74
    v_lshl_add_u32 v78, v72, 8, s73
    v_mul_u32_u24 v73, v78, v74
    v_cvt_f32_u32 v73, v73
    v_cvt_f32_u32 v78, v78
    v_mul_f32 v73, 0xba000000, v73
    v_mul_f32 v78, 0xba000000, v78
    v_and_b32 v75, 1, v2
    v_cvt_f32_u32 v75, v75
    v_mul_f32 v75, 0x3e800000, v75
    v_add_f32 v75, v75, v73
    v_mov_b32 v73, 0x3eb504f3
    v_fract_f32 v72, v75
    v_cos_f32 v76, v72
    v_sin_f32 v77, v72
    v_add_f32 v75, v75, v78
    v_mul_f32 v76, v76, v73
    v_mul_f32 v77, v77, v73
    v_cvt_pk_f16_f32 v68, v76, v77
    v_fract_f32 v72, v75
    v_cos_f32 v76, v72
    v_sin_f32 v77, v72
    v_add_f32 v75, v75, v78
    v_mul_f32 v76, v76, v73
    v_mul_f32 v77, v77, v73
    v_cvt_pk_f16_f32 v69, v76, v77
    v_fract_f32 v72, v75
    v_cos_f32 v76, v72
    v_sin_f32 v77, v72
    v_add_f32 v75, v75, v78
    v_mul_f32 v76, v76, v73
    v_mul_f32 v77, v77, v73
    v_cvt_pk_f16_f32 v70, v76, v77
    v_fract_f32 v72, v75
    v_cos_f32 v76, v72
    v_sin_f32 v77, v72
    v_mul_f32 v76, v76, v73
    v_mul_f32 v77, v77, v73
    v_cvt_pk_f16_f32 v71, v76, v77
    v_lshrrev_b32 v7, 5, v2
    v_and_b32 v72, 31, v2
    v_lshl_add_u32 v72, v4, 6, v72
    v_lshlrev_b32 v72, 2, v72
    v_lshl_add_u32 v72, v7, 12, v72
    v_lshlrev_b32 v73, 6, v6
    v_lshl_add_u32 v73, v5, 4, v73
    v_lshl_add_u32 v73, v4, 11, v73
    v_and_b32 v74, 0xc3, v10
    v_bfe_u32 v7, v10, 2, 2
    v_lshl_add_u32 v74, v7, 4, v74
    v_bfe_u32 v7, v10, 4, 2
    v_lshl_add_u32 v74, v7, 2, v74
    v_lshlrev_b32 v74, 2, v74
    v_and_b32 v7, 1, v5
    v_mul_u32_u24 v75, 229376, v7
    v_lshl_add_u32 v75, v6, 5, v75
    v_lshrrev_b32 v7, 1, v5
    v_lshl_add_u32 v75, v7, 4, v75
    s_waitcnt vmcnt(3)
    v_lshlrev_b32 v108, 16, v56
    v_and_b32 v109, 0xffff0000, v56
    v_lshlrev_b32 v110, 16, v57
    v_and_b32 v111, 0xffff0000, v57
    v_lshlrev_b32 v112, 16, v60
    v_and_b32 v113, 0xffff0000, v60
    v_lshlrev_b32 v114, 16, v61
    v_and_b32 v115, 0xffff0000, v61
    v_lshlrev_b32 v116, 16, v58
    v_and_b32 v117, 0xffff0000, v58
    v_lshlrev_b32 v118, 16, v59
    v_and_b32 v119, 0xffff0000, v59
    v_lshlrev_b32 v120, 16, v62
    v_and_b32 v121, 0xffff0000, v62
    v_lshlrev_b32 v122, 16, v63
    v_and_b32 v123, 0xffff0000, v63
    s_mov_b32 s6, 0
Z_pollT:
    buffer_load_dwordx4 v[20:23], v65, s[20:23], s90 offen sc1
    buffer_load_dwordx4 v[24:27], v65, s[20:23], s91 offen sc1
    s_add_u32 s6, s6, 1
    s_waitcnt vmcnt(0)
    v_and_b32 v7, v20, v24
    v_and_b32 v8, v23, v27
    v_and_b32 v7, v7, v8
    v_and_b32 v7, 1, v7
    v_cmp_eq_u32 vcc, 0, v7
    s_cmp_ge_u32 s6, 1048576
    s_cbranch_scc1 Z_pollT_done
    s_and_b64 exec, exec, vcc
    s_cbranch_execnz Z_pollT
Z_pollT_done:
    s_mov_b64 exec, -1
    s_nop 3
    v_mfma_f32_32x32x16_f16 v[76:91], v[68:71], v[20:23], 0
    v_mfma_f32_32x32x16_f16 v[92:107], v[68:71], v[24:27], 0
    s_nop 10
    v_cvt_pk_f16_f32 v20, v76, v77
    v_cvt_pk_f16_f32 v21, v78, v79
    v_cvt_pk_f16_f32 v22, v80, v81
    v_cvt_pk_f16_f32 v23, v82, v83
    ds_write2st64_b32 v72, v20, v21 offset0:0 offset1:4
    ds_write2st64_b32 v72, v22, v23 offset0:8 offset1:12
    v_cvt_pk_f16_f32 v24, v92, v93
    v_cvt_pk_f16_f32 v25, v94, v95
    v_cvt_pk_f16_f32 v26, v96, v97
    v_cvt_pk_f16_f32 v27, v98, v99
    v_add_u32 v7, 128, v72
    ds_write2st64_b32 v7, v24, v25 offset0:0 offset1:4
    ds_write2st64_b32 v7, v26, v27 offset0:8 offset1:12
    s_mov_b64 exec, 1
    ds_add_rtn_u32 v7, v18, v19 offset:24
    s_mov_b64 exec, -1
    s_mov_b32 s16, 0
    s_waitcnt lgkmcnt(0)
    v_readfirstlane_b32 s3, v7
    s_nop 0
    s_cmp_ge_u32 s3, 3
    s_cbranch_scc1 LB_done5
LB_spin5:
    ds_read_b32 v7, v18 offset:24
    s_add_u32 s16, s16, 1
    s_waitcnt lgkmcnt(0)
    v_readfirstlane_b32 s3, v7
    s_cmp_ge_u32 s16, 33554432
    s_cbranch_scc1 LB_done5
    s_cmp_lt_u32 s3, 4
    s_cbranch_scc1 LB_spin5
LB_done5:
    ds_read_b128 v[20:23], v73 offset:0
    ds_read_b128 v[24:27], v73 offset:1024
    s_waitcnt lgkmcnt(1)
    v_mfma_f32_16x16x32_f16 v[76:79], v[20:23], a[16:19], 0
    v_mfma_f32_16x16x32_f16 v[80:83], v[20:23], a[20:23], 0
    s_waitcnt lgkmcnt(0)
    v_mfma_f32_16x16x32_f16 v[84:87], v[24:27], a[16:19], 0
    v_mfma_f32_16x16x32_f16 v[88:91], v[24:27], a[20:23], 0
    s_nop 3
    v_pk_mul_f32 v[92:93], v[76:77], v[28:29]
    v_pk_mul_f32 v[96:97], v[80:81], v[28:29]
    v_pk_mul_f32 v[94:95], v[78:79], v[30:31]
    v_pk_mul_f32 v[98:99], v[82:83], v[30:31]
    v_pk_fma_f32 v[92:93], v[80:81], v[32:33], v[92:93] neg_lo:[1,0,0] neg_hi:[1,0,0]
    v_pk_fma_f32 v[96:97], v[76:77], v[32:33], v[96:97]
    v_pk_fma_f32 v[94:95], v[82:83], v[34:35], v[94:95] neg_lo:[1,0,0] neg_hi:[1,0,0]
    v_pk_fma_f32 v[98:99], v[78:79], v[34:35], v[98:99]
    v_cvt_pk_f16_f32 v20, v92, v96
    v_cvt_pk_f16_f32 v21, v93, v97
    v_cvt_pk_f16_f32 v22, v94, v98
    v_cvt_pk_f16_f32 v23, v95, v99
    s_nop 1
    v_mfma_f32_16x16x32_f16 v[76:79], v[20:23], a[24:27], 0
    v_mfma_f32_16x16x32_f16 v[80:83], v[20:23], a[28:31], 0
    v_pk_mul_f32 v[100:101], v[84:85], v[28:29]
    v_pk_mul_f32 v[104:105], v[88:89], v[28:29]
    v_pk_mul_f32 v[102:103], v[86:87], v[30:31]
    v_pk_mul_f32 v[106:107], v[90:91], v[30:31]
    v_pk_fma_f32 v[100:101], v[88:89], v[32:33], v[100:101] neg_lo:[1,0,0] neg_hi:[1,0,0]
    v_pk_fma_f32 v[104:105], v[84:85], v[32:33], v[104:105]
    v_pk_fma_f32 v[102:103], v[90:91], v[34:35], v[102:103] neg_lo:[1,0,0] neg_hi:[1,0,0]
    v_pk_fma_f32 v[106:107], v[86:87], v[34:35], v[106:107]
    v_cvt_pk_f16_f32 v24, v100, v104
    v_cvt_pk_f16_f32 v25, v101, v105
    v_cvt_pk_f16_f32 v26, v102, v106
    v_cvt_pk_f16_f32 v27, v103, v107
    s_nop 1
    v_mfma_f32_16x16x32_f16 v[84:87], v[24:27], a[24:27], 0
    v_mfma_f32_16x16x32_f16 v[88:91], v[24:27], a[28:31], 0
    v_pk_mul_f32 v[76:77], v[76:77], v[54:55] op_sel_hi:[1,0]
    v_pk_mul_f32 v[78:79], v[78:79], v[54:55] op_sel_hi:[1,0]
    v_pk_mul_f32 v[80:81], v[80:81], v[54:55] op_sel_hi:[1,0]
    v_pk_mul_f32 v[82:83], v[82:83], v[54:55] op_sel_hi:[1,0]
    s_nop 2
    v_pk_mul_f32 v[84:85], v[84:85], v[54:55] op_sel_hi:[1,0]
    v_pk_mul_f32 v[86:87], v[86:87], v[54:55] op_sel_hi:[1,0]
    v_pk_mul_f32 v[88:89], v[88:89], v[54:55] op_sel_hi:[1,0]
    v_pk_mul_f32 v[90:91], v[90:91], v[54:55] op_sel_hi:[1,0]
    v_cvt_pk_bf16_f32 v77, v76, v77
    v_cvt_pk_bf16_f32 v79, v78, v79
    v_cvt_pk_bf16_f32 v81, v80, v81
    v_cvt_pk_bf16_f32 v83, v82, v83
    v_cvt_pk_bf16_f32 v85, v84, v85
    v_cvt_pk_bf16_f32 v87, v86, v87
    v_cvt_pk_bf16_f32 v89, v88, v89
    v_cvt_pk_bf16_f32 v91, v90, v91
    v_lshlrev_b32 v76, 16, v77
    v_and_b32 v77, 0xffff0000, v77
    v_lshlrev_b32 v78, 16, v79
    v_and_b32 v79, 0xffff0000, v79
    v_lshlrev_b32 v80, 16, v81
    v_and_b32 v81, 0xffff0000, v81
    v_lshlrev_b32 v82, 16, v83
    v_and_b32 v83, 0xffff0000, v83
    v_lshlrev_b32 v84, 16, v85
    v_and_b32 v85, 0xffff0000, v85
    v_lshlrev_b32 v86, 16, v87
    v_and_b32 v87, 0xffff0000, v87
    v_lshlrev_b32 v88, 16, v89
    v_and_b32 v89, 0xffff0000, v89
    v_lshlrev_b32 v90, 16, v91
    v_and_b32 v91, 0xffff0000, v91
    v_pk_add_f32 v[76:77], v[76:77], v[108:109]
    v_pk_add_f32 v[78:79], v[78:79], v[110:111]
    v_pk_add_f32 v[80:81], v[80:81], v[112:113]
    v_pk_add_f32 v[82:83], v[82:83], v[114:115]
    v_pk_add_f32 v[84:85], v[84:85], v[116:117]
    v_pk_add_f32 v[86:87], v[86:87], v[118:119]
    v_pk_add_f32 v[88:89], v[88:89], v[120:121]
    v_pk_add_f32 v[90:91], v[90:91], v[122:123]
    v_cvt_pk_bf16_f32 v56, v76, v77
    v_cvt_pk_bf16_f32 v57, v78, v79
    v_cvt_pk_bf16_f32 v60, v80, v81
    v_cvt_pk_bf16_f32 v61, v82, v83
    v_cvt_pk_bf16_f32 v58, v84, v85
    v_cvt_pk_bf16_f32 v59, v86, v87
    v_cvt_pk_bf16_f32 v62, v88, v89
    v_cvt_pk_bf16_f32 v63, v90, v91
    v_lshlrev_b32 v76, 16, v56
    v_and_b32 v77, 0xffff0000, v56
    v_lshlrev_b32 v78, 16, v57
    v_and_b32 v79, 0xffff0000, v57
    v_lshlrev_b32 v80, 16, v60
    v_and_b32 v81, 0xffff0000, v60
    v_lshlrev_b32 v82, 16, v61
    v_and_b32 v83, 0xffff0000, v61
    v_lshlrev_b32 v84, 16, v58
    v_and_b32 v85, 0xffff0000, v58
    v_lshlrev_b32 v86, 16, v59
    v_and_b32 v87, 0xffff0000, v59
    v_lshlrev_b32 v88, 16, v62
    v_and_b32 v89, 0xffff0000, v62
    v_lshlrev_b32 v90, 16, v63
    v_and_b32 v91, 0xffff0000, v63
    v_permlane16_swap_b32 v56, v58
    v_permlane16_swap_b32 v57, v59
    v_permlane16_swap_b32 v60, v62
    v_permlane16_swap_b32 v61, v63
    buffer_store_dwordx4 v[56:59], v75, s[36:39], s80 offen sc1
    s_mov_b32 exec_lo, 0xfff0fff
    s_mov_b32 exec_hi, 0xfff0fff
    buffer_store_dwordx4 v[60:63], v75, s[36:39], s80 offen offset:512 sc1
    s_mov_b64 exec, -1
    v_readfirstlane_b32 s92, v76
    v_readfirstlane_b32 s93, v84
    v_mov_b32 v108, 0
    v_mov_b32 v109, 0
    v_mov_b32 v112, 0
    v_mov_b32 v113, 0
    v_mov_b32 v110, 0
    v_mov_b32 v111, 0
    v_mov_b32 v114, 0
    v_mov_b32 v115, 0
    v_pk_add_f32 v[116:117], v[76:77], s[92:93] op_sel:[0,0] op_sel_hi:[1,0] neg_lo:[0,1] neg_hi:[0,1]
    v_pk_fma_f32 v[108:109], v[116:117], v[116:117], v[108:109]
    v_pk_add_f32 v[112:113], v[112:113], v[116:117]
    v_pk_add_f32 v[118:119], v[84:85], s[92:93] op_sel:[0,1] op_sel_hi:[1,1] neg_lo:[0,1] neg_hi:[0,1]
    v_pk_fma_f32 v[110:111], v[118:119], v[118:119], v[110:111]
    v_pk_add_f32 v[114:115], v[114:115], v[118:119]
    v_pk_add_f32 v[120:121], v[78:79], s[92:93] op_sel:[0,0] op_sel_hi:[1,0] neg_lo:[0,1] neg_hi:[0,1]
    v_pk_fma_f32 v[108:109], v[120:121], v[120:121], v[108:109]
    v_pk_add_f32 v[112:113], v[112:113], v[120:121]
    v_pk_add_f32 v[122:123], v[86:87], s[92:93] op_sel:[0,1] op_sel_hi:[1,1] neg_lo:[0,1] neg_hi:[0,1]
    v_pk_fma_f32 v[110:111], v[122:123], v[122:123], v[110:111]
    v_pk_add_f32 v[114:115], v[114:115], v[122:123]
    s_mov_b32 exec_lo, 0xfff0fff
    s_mov_b32 exec_hi, 0xfff0fff
    v_pk_add_f32 v[116:117], v[80:81], s[92:93] op_sel:[0,0] op_sel_hi:[1,0] neg_lo:[0,1] neg_hi:[0,1]
    v_pk_fma_f32 v[108:109], v[116:117], v[116:117], v[108:109]
    v_pk_add_f32 v[112:113], v[112:113], v[116:117]
    v_pk_add_f32 v[118:119], v[88:89], s[92:93] op_sel:[0,1] op_sel_hi:[1,1] neg_lo:[0,1] neg_hi:[0,1]
    v_pk_fma_f32 v[110:111], v[118:119], v[118:119], v[110:111]
    v_pk_add_f32 v[114:115], v[114:115], v[118:119]
    v_pk_add_f32 v[120:121], v[82:83], s[92:93] op_sel:[0,0] op_sel_hi:[1,0] neg_lo:[0,1] neg_hi:[0,1]
    v_pk_fma_f32 v[108:109], v[120:121], v[120:121], v[108:109]
    v_pk_add_f32 v[112:113], v[112:113], v[120:121]
    v_pk_add_f32 v[122:123], v[90:91], s[92:93] op_sel:[0,1] op_sel_hi:[1,1] neg_lo:[0,1] neg_hi:[0,1]
    v_pk_fma_f32 v[110:111], v[122:123], v[122:123], v[110:111]
    v_pk_add_f32 v[114:115], v[114:115], v[122:123]
    s_mov_b64 exec, -1
    v_add_f32 v112, v112, v113
    v_add_f32 v108, v108, v109
    v_add_f32 v114, v114, v115
    v_add_f32 v110, v110, v111
    s_nop 0
    v_permlane32_swap_b32 v112, v114
    v_permlane32_swap_b32 v108, v110
    v_add_f32 v112, v112, v114
    v_add_f32 v108, v108, v110
    s_nop 1
    v_permlane16_swap_b32 v112, v108
    v_add_f32 v112, v112, v108
    s_nop 1
    v_add_f32_dpp v112, v112, v112 quad_perm:[1,0,3,2] row_mask:0xf bank_mask:0xf
    s_nop 1
    v_add_f32_dpp v112, v112, v112 quad_perm:[2,3,0,1] row_mask:0xf bank_mask:0xf
    s_nop 1
    v_add_f32_dpp v112, v112, v112 row_half_mirror row_mask:0xf bank_mask:0xf
    s_nop 1
    v_add_f32_dpp v112, v112, v112 row_mirror row_mask:0xf bank_mask:0xf
    s_nop 0
    v_readlane_b32 s94, v112, 0
    v_readlane_b32 s95, v112, 32
    v_readlane_b32 s96, v112, 16
    v_readlane_b32 s97, v112, 48
    v_pk_mul_f32 v[116:117], s[94:95], v[66:67] op_sel_hi:[1,0]
    s_nop 0
    v_pk_mul_f32 v[118:119], s[96:97], v[66:67] op_sel_hi:[1,0]
    v_pk_fma_f32 v[118:119], v[116:117], v[116:117], v[118:119] neg_lo:[1,0,0] neg_hi:[1,0,0]
    v_pk_add_f32 v[116:117], v[116:117], s[92:93]
    v_cvt_pk_bf16_f32 v122, v118, v119
    v_cvt_pk_bf16_f32 v123, v116, v117
    v_lshlrev_b32 v118, 16, v122
    v_and_b32 v119, 0xffff0000, v122
    v_lshlrev_b32 v120, 16, v123
    v_and_b32 v121, 0xffff0000, v123
    v_pk_add_f32 v[118:119], v[118:119], v[66:67] op_sel:[0,1] op_sel_hi:[1,1]
    v_cvt_pk_bf16_f32 v122, v118, v119
    v_lshlrev_b32 v118, 16, v122
    v_and_b32 v119, 0xffff0000, v122
    v_sqrt_f32 v118, v118
    v_sqrt_f32 v119, v119
    s_nop 0
    v_cvt_pk_bf16_f32 v122, v118, v119
    v_lshlrev_b32 v118, 16, v122
    v_and_b32 v119, 0xffff0000, v122
    v_rcp_f32 v118, v118
    v_rcp_f32 v119, v119
    v_pk_add_f32 v[76:77], v[76:77], v[120:121] op_sel:[0,0] op_sel_hi:[1,0] neg_lo:[0,1] neg_hi:[0,1]
    v_pk_add_f32 v[84:85], v[84:85], v[120:121] op_sel:[0,1] op_sel_hi:[1,1] neg_lo:[0,1] neg_hi:[0,1]
    v_pk_add_f32 v[78:79], v[78:79], v[120:121] op_sel:[0,0] op_sel_hi:[1,0] neg_lo:[0,1] neg_hi:[0,1]
    v_pk_add_f32 v[86:87], v[86:87], v[120:121] op_sel:[0,1] op_sel_hi:[1,1] neg_lo:[0,1] neg_hi:[0,1]
    v_cvt_pk_bf16_f32 v77, v76, v77
    v_cvt_pk_bf16_f32 v85, v84, v85
    v_cvt_pk_bf16_f32 v79, v78, v79
    v_cvt_pk_bf16_f32 v87, v86, v87
    v_lshlrev_b32 v76, 16, v77
    v_and_b32 v77, 0xffff0000, v77
    v_lshlrev_b32 v84, 16, v85
    v_and_b32 v85, 0xffff0000, v85
    v_lshlrev_b32 v78, 16, v79
    v_and_b32 v79, 0xffff0000, v79
    v_lshlrev_b32 v86, 16, v87
    v_and_b32 v87, 0xffff0000, v87
    v_pk_mul_f32 v[76:77], v[76:77], v[118:119] op_sel:[0,0] op_sel_hi:[1,0]
    v_pk_mul_f32 v[84:85], v[84:85], v[118:119] op_sel:[0,1] op_sel_hi:[1,1]
    v_pk_mul_f32 v[78:79], v[78:79], v[118:119] op_sel:[0,0] op_sel_hi:[1,0]
    v_pk_mul_f32 v[86:87], v[86:87], v[118:119] op_sel:[0,1] op_sel_hi:[1,1]
    s_mov_b32 exec_lo, 0xfff0fff
    s_mov_b32 exec_hi, 0xfff0fff
    v_pk_add_f32 v[80:81], v[80:81], v[120:121] op_sel:[0,0] op_sel_hi:[1,0] neg_lo:[0,1] neg_hi:[0,1]
    v_pk_add_f32 v[88:89], v[88:89], v[120:121] op_sel:[0,1] op_sel_hi:[1,1] neg_lo:[0,1] neg_hi:[0,1]
    v_pk_add_f32 v[82:83], v[82:83], v[120:121] op_sel:[0,0] op_sel_hi:[1,0] neg_lo:[0,1] neg_hi:[0,1]
    v_pk_add_f32 v[90:91], v[90:91], v[120:121] op_sel:[0,1] op_sel_hi:[1,1] neg_lo:[0,1] neg_hi:[0,1]
    v_cvt_pk_bf16_f32 v81, v80, v81
    v_cvt_pk_bf16_f32 v89, v88, v89
    v_cvt_pk_bf16_f32 v83, v82, v83
    v_cvt_pk_bf16_f32 v91, v90, v91
    v_lshlrev_b32 v80, 16, v81
    v_and_b32 v81, 0xffff0000, v81
    v_lshlrev_b32 v88, 16, v89
    v_and_b32 v89, 0xffff0000, v89
    v_lshlrev_b32 v82, 16, v83
    v_and_b32 v83, 0xffff0000, v83
    v_lshlrev_b32 v90, 16, v91
    v_and_b32 v91, 0xffff0000, v91
    v_pk_mul_f32 v[80:81], v[80:81], v[118:119] op_sel:[0,0] op_sel_hi:[1,0]
    v_pk_mul_f32 v[88:89], v[88:89], v[118:119] op_sel:[0,1] op_sel_hi:[1,1]
    v_pk_mul_f32 v[82:83], v[82:83], v[118:119] op_sel:[0,0] op_sel_hi:[1,0]
    v_pk_mul_f32 v[90:91], v[90:91], v[118:119] op_sel:[0,1] op_sel_hi:[1,1]
    s_mov_b64 exec, -1
    v_cvt_pk_bf16_f32 v77, v76, v77
    v_cvt_pk_bf16_f32 v79, v78, v79
    v_cvt_pk_bf16_f32 v81, v80, v81
    v_cvt_pk_bf16_f32 v83, v82, v83
    v_cvt_pk_bf16_f32 v85, v84, v85
    v_cvt_pk_bf16_f32 v87, v86, v87
    v_cvt_pk_bf16_f32 v89, v88, v89
    v_cvt_pk_bf16_f32 v91, v90, v91
    v_lshlrev_b32 v76, 16, v77
    v_and_b32 v77, 0xffff0000, v77
    v_lshlrev_b32 v78, 16, v79
    v_and_b32 v79, 0xffff0000, v79
    v_lshlrev_b32 v80, 16, v81
    v_and_b32 v81, 0xffff0000, v81
    v_lshlrev_b32 v82, 16, v83
    v_and_b32 v83, 0xffff0000, v83
    v_lshlrev_b32 v84, 16, v85
    v_and_b32 v85, 0xffff0000, v85
    v_lshlrev_b32 v86, 16, v87
    v_and_b32 v87, 0xffff0000, v87
    v_lshlrev_b32 v88, 16, v89
    v_and_b32 v89, 0xffff0000, v89
    v_lshlrev_b32 v90, 16, v91
    v_and_b32 v91, 0xffff0000, v91
    v_readfirstlane_b32 s92, v76
    v_readfirstlane_b32 s93, v84
    v_mov_b32 v108, 0
    v_mov_b32 v109, 0
    v_mov_b32 v112, 0
    v_mov_b32 v113, 0
    v_mov_b32 v110, 0
    v_mov_b32 v111, 0
    v_mov_b32 v114, 0
    v_mov_b32 v115, 0
    v_pk_add_f32 v[116:117], v[76:77], s[92:93] op_sel:[0,0] op_sel_hi:[1,0] neg_lo:[0,1] neg_hi:[0,1]
    v_pk_fma_f32 v[108:109], v[116:117], v[116:117], v[108:109]
    v_pk_add_f32 v[112:113], v[112:113], v[116:117]
    v_pk_add_f32 v[118:119], v[84:85], s[92:93] op_sel:[0,1] op_sel_hi:[1,1] neg_lo:[0,1] neg_hi:[0,1]
    v_pk_fma_f32 v[110:111], v[118:119], v[118:119], v[110:111]
    v_pk_add_f32 v[114:115], v[114:115], v[118:119]
    v_pk_add_f32 v[120:121], v[78:79], s[92:93] op_sel:[0,0] op_sel_hi:[1,0] neg_lo:[0,1] neg_hi:[0,1]
    v_pk_fma_f32 v[108:109], v[120:121], v[120:121], v[108:109]
    v_pk_add_f32 v[112:113], v[112:113], v[120:121]
    v_pk_add_f32 v[122:123], v[86:87], s[92:93] op_sel:[0,1] op_sel_hi:[1,1] neg_lo:[0,1] neg_hi:[0,1]
    v_pk_fma_f32 v[110:111], v[122:123], v[122:123], v[110:111]
    v_pk_add_f32 v[114:115], v[114:115], v[122:123]
    s_mov_b32 exec_lo, 0xfff0fff
    s_mov_b32 exec_hi, 0xfff0fff
    v_pk_add_f32 v[116:117], v[80:81], s[92:93] op_sel:[0,0] op_sel_hi:[1,0] neg_lo:[0,1] neg_hi:[0,1]
    v_pk_fma_f32 v[108:109], v[116:117], v[116:117], v[108:109]
    v_pk_add_f32 v[112:113], v[112:113], v[116:117]
    v_pk_add_f32 v[118:119], v[88:89], s[92:93] op_sel:[0,1] op_sel_hi:[1,1] neg_lo:[0,1] neg_hi:[0,1]
    v_pk_fma_f32 v[110:111], v[118:119], v[118:119], v[110:111]
    v_pk_add_f32 v[114:115], v[114:115], v[118:119]
    v_pk_add_f32 v[120:121], v[82:83], s[92:93] op_sel:[0,0] op_sel_hi:[1,0] neg_lo:[0,1] neg_hi:[0,1]
    v_pk_fma_f32 v[108:109], v[120:121], v[120:121], v[108:109]
    v_pk_add_f32 v[112:113], v[112:113], v[120:121]
    v_pk_add_f32 v[122:123], v[90:91], s[92:93] op_sel:[0,1] op_sel_hi:[1,1] neg_lo:[0,1] neg_hi:[0,1]
    v_pk_fma_f32 v[110:111], v[122:123], v[122:123], v[110:111]
    v_pk_add_f32 v[114:115], v[114:115], v[122:123]
    s_mov_b64 exec, -1
    v_add_f32 v112, v112, v113
    v_add_f32 v108, v108, v109
    v_add_f32 v114, v114, v115
    v_add_f32 v110, v110, v111
    s_nop 0
    v_permlane32_swap_b32 v112, v114
    v_permlane32_swap_b32 v108, v110
    v_add_f32 v112, v112, v114
    v_add_f32 v108, v108, v110
    s_nop 1
    v_permlane16_swap_b32 v112, v108
    v_add_f32 v112, v112, v108
    s_nop 1
    v_add_f32_dpp v112, v112, v112 quad_perm:[1,0,3,2] row_mask:0xf bank_mask:0xf
    s_nop 1
    v_add_f32_dpp v112, v112, v112 quad_perm:[2,3,0,1] row_mask:0xf bank_mask:0xf
    s_nop 1
    v_add_f32_dpp v112, v112, v112 row_half_mirror row_mask:0xf bank_mask:0xf
    s_nop 1
    v_add_f32_dpp v112, v112, v112 row_mirror row_mask:0xf bank_mask:0xf
    s_nop 0
    v_readlane_b32 s94, v112, 0
    v_readlane_b32 s95, v112, 32
    v_readlane_b32 s96, v112, 16
    v_readlane_b32 s97, v112, 48
    v_pk_mul_f32 v[116:117], s[94:95], v[66:67] op_sel_hi:[1,0]
    s_nop 0
    v_pk_mul_f32 v[118:119], s[96:97], v[66:67] op_sel_hi:[1,0]
    v_pk_fma_f32 v[118:119], v[116:117], v[116:117], v[118:119] neg_lo:[1,0,0] neg_hi:[1,0,0]
    v_pk_add_f32 v[116:117], v[116:117], s[92:93]
    v_cvt_pk_bf16_f32 v122, v118, v119
    v_cvt_pk_bf16_f32 v123, v116, v117
    v_lshlrev_b32 v118, 16, v122
    v_and_b32 v119, 0xffff0000, v122
    v_lshlrev_b32 v120, 16, v123
    v_and_b32 v121, 0xffff0000, v123
    v_pk_add_f32 v[118:119], v[118:119], v[66:67] op_sel:[0,1] op_sel_hi:[1,1]
    v_cvt_pk_bf16_f32 v122, v118, v119
    v_lshlrev_b32 v118, 16, v122
    v_and_b32 v119, 0xffff0000, v122
    v_sqrt_f32 v118, v118
    v_sqrt_f32 v119, v119
    s_nop 0
    v_cvt_pk_bf16_f32 v122, v118, v119
    v_lshlrev_b32 v118, 16, v122
    v_and_b32 v119, 0xffff0000, v122
    v_rcp_f32 v118, v118
    v_rcp_f32 v119, v119
    v_pk_add_f32 v[76:77], v[76:77], v[120:121] op_sel:[0,0] op_sel_hi:[1,0] neg_lo:[0,1] neg_hi:[0,1]
    v_pk_add_f32 v[84:85], v[84:85], v[120:121] op_sel:[0,1] op_sel_hi:[1,1] neg_lo:[0,1] neg_hi:[0,1]
    v_pk_add_f32 v[78:79], v[78:79], v[120:121] op_sel:[0,0] op_sel_hi:[1,0] neg_lo:[0,1] neg_hi:[0,1]
    v_pk_add_f32 v[86:87], v[86:87], v[120:121] op_sel:[0,1] op_sel_hi:[1,1] neg_lo:[0,1] neg_hi:[0,1]
    v_cvt_pk_bf16_f32 v77, v76, v77
    v_cvt_pk_bf16_f32 v85, v84, v85
    v_cvt_pk_bf16_f32 v79, v78, v79
    v_cvt_pk_bf16_f32 v87, v86, v87
    v_lshlrev_b32 v76, 16, v77
    v_and_b32 v77, 0xffff0000, v77
    v_lshlrev_b32 v84, 16, v85
    v_and_b32 v85, 0xffff0000, v85
    v_lshlrev_b32 v78, 16, v79
    v_and_b32 v79, 0xffff0000, v79
    v_lshlrev_b32 v86, 16, v87
    v_and_b32 v87, 0xffff0000, v87
    v_pk_mul_f32 v[76:77], v[76:77], v[118:119] op_sel:[0,0] op_sel_hi:[1,0]
    v_pk_mul_f32 v[84:85], v[84:85], v[118:119] op_sel:[0,1] op_sel_hi:[1,1]
    v_pk_mul_f32 v[78:79], v[78:79], v[118:119] op_sel:[0,0] op_sel_hi:[1,0]
    v_pk_mul_f32 v[86:87], v[86:87], v[118:119] op_sel:[0,1] op_sel_hi:[1,1]
    s_mov_b32 exec_lo, 0xfff0fff
    s_mov_b32 exec_hi, 0xfff0fff
    v_pk_add_f32 v[80:81], v[80:81], v[120:121] op_sel:[0,0] op_sel_hi:[1,0] neg_lo:[0,1] neg_hi:[0,1]
    v_pk_add_f32 v[88:89], v[88:89], v[120:121] op_sel:[0,1] op_sel_hi:[1,1] neg_lo:[0,1] neg_hi:[0,1]
    v_pk_add_f32 v[82:83], v[82:83], v[120:121] op_sel:[0,0] op_sel_hi:[1,0] neg_lo:[0,1] neg_hi:[0,1]
    v_pk_add_f32 v[90:91], v[90:91], v[120:121] op_sel:[0,1] op_sel_hi:[1,1] neg_lo:[0,1] neg_hi:[0,1]
    v_cvt_pk_bf16_f32 v81, v80, v81
    v_cvt_pk_bf16_f32 v89, v88, v89
    v_cvt_pk_bf16_f32 v83, v82, v83
    v_cvt_pk_bf16_f32 v91, v90, v91
    v_lshlrev_b32 v80, 16, v81
    v_and_b32 v81, 0xffff0000, v81
    v_lshlrev_b32 v88, 16, v89
    v_and_b32 v89, 0xffff0000, v89
    v_lshlrev_b32 v82, 16, v83
    v_and_b32 v83, 0xffff0000, v83
    v_lshlrev_b32 v90, 16, v91
    v_and_b32 v91, 0xffff0000, v91
    v_pk_mul_f32 v[80:81], v[80:81], v[118:119] op_sel:[0,0] op_sel_hi:[1,0]
    v_pk_mul_f32 v[88:89], v[88:89], v[118:119] op_sel:[0,1] op_sel_hi:[1,1]
    v_pk_mul_f32 v[82:83], v[82:83], v[118:119] op_sel:[0,0] op_sel_hi:[1,0]
    v_pk_mul_f32 v[90:91], v[90:91], v[118:119] op_sel:[0,1] op_sel_hi:[1,1]
    s_mov_b64 exec, -1
    v_cvt_pk_bf16_f32 v20, v76, v84
    v_cvt_pk_bf16_f32 v21, v77, v85
    v_cvt_pk_bf16_f32 v22, v78, v86
    v_cvt_pk_bf16_f32 v23, v79, v87
    ds_write_b128 v73, v[20:23] offset:8192
    v_cvt_pk_bf16_f32 v24, v80, v88
    v_cvt_pk_bf16_f32 v25, v81, v89
    v_cvt_pk_bf16_f32 v26, v82, v90
    v_cvt_pk_bf16_f32 v27, v83, v91
    ds_write_b128 v73, v[24:27] offset:9216
    s_waitcnt vmcnt(0)
    s_mov_b64 exec, 1
    ds_add_rtn_u32 v7, v18, v19 offset:28
    s_mov_b64 exec, -1
    s_mov_b32 s16, 0
    s_waitcnt lgkmcnt(0)
    v_readfirstlane_b32 s3, v7
    s_nop 0
    s_cmp_ge_u32 s3, 7
    s_cbranch_scc1 LB_done6
LB_spin6:
    ds_read_b32 v7, v18 offset:28
    s_add_u32 s16, s16, 1
    s_waitcnt lgkmcnt(0)
    v_readfirstlane_b32 s3, v7
    s_cmp_ge_u32 s16, 33554432
    s_cbranch_scc1 LB_done6
    s_cmp_lt_u32 s3, 8
    s_cbranch_scc1 LB_spin6
LB_done6:
    ds_read2st64_b32 v[92:93], v74 offset0:32 offset1:40
    ds_read2st64_b32 v[94:95], v74 offset0:48 offset1:56
    ds_read2st64_b32 v[96:97], v74 offset0:36 offset1:44
    ds_read2st64_b32 v[98:99], v74 offset0:52 offset1:60
    s_waitcnt lgkmcnt(2)
    buffer_store_dwordx4 v[92:95], v11, s[40:43], s82 offen sc1
    s_waitcnt lgkmcnt(0)
    buffer_store_dwordx4 v[96:99], v11, s[40:43], s83 offen sc1
    s_mov_b64 exec, 1
    ds_add_u32 v18, v19 offset:52
    s_mov_b64 exec, -1
    s_setprio 0
    s_barrier
    ds_read_b64_tr_b16 a[0:1], v14 offset:0
    ds_read_b64_tr_b16 a[2:3], v14 offset:2048
    ds_read_b64_tr_b16 a[4:5], v15 offset:0
    ds_read_b64_tr_b16 a[6:7], v15 offset:2048
    ds_read_b64_tr_b16 a[8:9], v16 offset:0
    ds_read_b64_tr_b16 a[10:11], v16 offset:2048
    ds_read_b64_tr_b16 a[12:13], v17 offset:0
    ds_read_b64_tr_b16 a[14:15], v17 offset:2048
    ds_read_b64_tr_b16 a[16:17], v14 offset:4096
    ds_read_b64_tr_b16 a[18:19], v14 offset:6144
    ds_read_b64_tr_b16 a[20:21], v15 offset:4096
    ds_read_b64_tr_b16 a[22:23], v15 offset:6144
    ds_read_b64_tr_b16 a[24:25], v16 offset:4096
    ds_read_b64_tr_b16 a[26:27], v16 offset:6144
    ds_read_b64_tr_b16 a[28:29], v17 offset:4096
    ds_read_b64_tr_b16 a[30:31], v17 offset:6144
    ds_read_b64_tr_b16 a[32:33], v14 offset:8192
    ds_read_b64_tr_b16 a[34:35], v14 offset:10240
    ds_read_b64_tr_b16 a[36:37], v15 offset:8192
    ds_read_b64_tr_b16 a[38:39], v15 offset:10240
    ds_read_b64_tr_b16 a[40:41], v16 offset:8192
    ds_read_b64_tr_b16 a[42:43], v16 offset:10240
    ds_read_b64_tr_b16 a[44:45], v17 offset:8192
    ds_read_b64_tr_b16 a[46:47], v17 offset:10240
    ds_read_b64_tr_b16 a[48:49], v14 offset:12288
    ds_read_b64_tr_b16 a[50:51], v14 offset:14336
    ds_read_b64_tr_b16 a[52:53], v15 offset:12288
    ds_read_b64_tr_b16 a[54:55], v15 offset:14336
    ds_read_b64_tr_b16 a[56:57], v16 offset:12288
    ds_read_b64_tr_b16 a[58:59], v16 offset:14336
    ds_read_b64_tr_b16 a[60:61], v17 offset:12288
    ds_read_b64_tr_b16 a[62:63], v17 offset:14336
    v_add_u32 v76, 65536, v14
    v_add_u32 v77, 65536, v15
    v_add_u32 v78, 65536, v16
    v_add_u32 v79, 65536, v17
    ds_read_b64_tr_b16 a[64:65], v76 offset:0
    ds_read_b64_tr_b16 a[66:67], v76 offset:2048
    ds_read_b64_tr_b16 a[68:69], v77 offset:0
    ds_read_b64_tr_b16 a[70:71], v77 offset:2048
    ds_read_b64_tr_b16 a[72:73], v78 offset:0
    ds_read_b64_tr_b16 a[74:75], v78 offset:2048
    ds_read_b64_tr_b16 a[76:77], v79 offset:0
    ds_read_b64_tr_b16 a[78:79], v79 offset:2048
    ds_read_b64_tr_b16 a[80:81], v76 offset:4096
    ds_read_b64_tr_b16 a[82:83], v76 offset:6144
    ds_read_b64_tr_b16 a[84:85], v77 offset:4096
    ds_read_b64_tr_b16 a[86:87], v77 offset:6144
    ds_read_b64_tr_b16 a[88:89], v78 offset:4096
    ds_read_b64_tr_b16 a[90:91], v78 offset:6144
    ds_read_b64_tr_b16 a[92:93], v79 offset:4096
    ds_read_b64_tr_b16 a[94:95], v79 offset:6144
    ds_read_b64_tr_b16 a[96:97], v76 offset:8192
    ds_read_b64_tr_b16 a[98:99], v76 offset:10240
    ds_read_b64_tr_b16 a[100:101], v77 offset:8192
    ds_read_b64_tr_b16 a[102:103], v77 offset:10240
    ds_read_b64_tr_b16 a[104:105], v78 offset:8192
    ds_read_b64_tr_b16 a[106:107], v78 offset:10240
    ds_read_b64_tr_b16 a[108:109], v79 offset:8192
    ds_read_b64_tr_b16 a[110:111], v79 offset:10240
    ds_read_b64_tr_b16 a[112:113], v76 offset:12288
    ds_read_b64_tr_b16 a[114:115], v76 offset:14336
    ds_read_b64_tr_b16 a[116:117], v77 offset:12288
    ds_read_b64_tr_b16 a[118:119], v77 offset:14336
    ds_read_b64_tr_b16 a[120:121], v78 offset:12288
    ds_read_b64_tr_b16 a[122:123], v78 offset:14336
    ds_read_b64_tr_b16 a[124:125], v79 offset:12288
    ds_read_b64_tr_b16 a[126:127], v79 offset:14336
    s_waitcnt lgkmcnt(0)
    s_branch Z_join
Z_agent:
    s_mov_b32 s48, s8
    s_mov_b32 s49, s9
    s_mov_b32 s56, s10
    s_mov_b32 s57, s11
    s_mov_b32 s52, s12
    s_mov_b32 s53, s13
    s_mov_b32 s60, s14
    s_mov_b32 s61, s15
    s_mov_b32 s64, s16
    s_mov_b32 s65, s17
    s_mov_b32 s12, s18
    s_mov_b32 s13, s19
    s_mov_b32 s8, s6
    s_mov_b32 s9, s7
    s_mov_b32 s14, 256
    s_mov_b32 s15, 0x20000
    s_mov_b32 s10, 921600
    s_mov_b32 s11, 0x20000
    s_mov_b32 s6, 921600
    s_mov_b32 s7, 0x20000
    s_add_u32 s24, s20, 2097152
    s_addc_u32 s25, s21, 0
    s_add_u32 s36, s20, 7340032
    s_addc_u32 s37, s21, 0
    s_add_u32 s40, s20, 9437184
    s_addc_u32 s41, s21, 0
    s_add_u32 s44, s20, 11534336
    s_addc_u32 s45, s21, 0
    s_and_b32 s18, s72, 3
    s_lshl_b32 s19, s18, 1
    s_lshr_b32 s3, s72, 2
    s_add_u32 s19, s19, s3
    s_mul_i32 s3, s101, 28
    s_add_u32 s3, s3, s100
    s_mul_i32 s74, s3, 9363
    s_lshr_b32 s74, s74, 16
    s_mul_i32 s75, s74, 7
    s_sub_u32 s75, s3, s75
    s_cmp_lt_u32 s100, 28
    s_cselect_b32 s77, 1, 0
    s_cmp_lt_u32 s3, 196
    s_cselect_b32 s76, s77, 0
    s_mul_i32 s79, s73, 8192
    s_add_u32 s79, s79, 4194304
    s_lshl_b32 s82, s73, 8
    s_add_u32 s83, s82, 0x100000
    s_lshl_b32 s85, s72, 14
    s_add_u32 s85, s85, 16384
    s_lshl_b32 s3, s74, 7
    s_mul_i32 s86, s19, 114688
    s_add_u32 s86, s86, s3
    s_mul_i32 s87, s19, 917504
    s_add_u32 s87, s87, s3
    s_cmp_eq_u32 s76, 0
    s_cselect_b32 s86, 0x10000000, s86
    s_lshl_b32 s89, s100, 6
    s_add_u32 s89, s89, s18
    s_mul_i32 s89, s89, 3584
    s_lshl_b32 s3, s101, 9
    s_add_u32 s89, s89, s3
    s_cmp_eq_u32 s101, 7
    s_cselect_b32 s89, 0x10000000, s89
    v_mov_b32 v28, 0
    v_and_b32 v7, 31, v10
    v_lshlrev_b32 v7, 4, v7
    v_lshrrev_b32 v8, 5, v10
    v_mul_u32_u24 v58, 3584, v8
    v_add_u32 v58, v58, v7
    s_mul_i32 s89, s100, 229376
    s_lshl_b32 s3, s101, 9
    s_add_u32 s89, s89, s3
    s_cmp_eq_u32 s101, 7
    s_cselect_b32 s89, 0x10000000, s89
    v_and_b32 v57, 1, v10
    v_bfe_u32 v7, v10, 1, 4
    v_mul_u32_u24 v7, 28, v7
    v_lshrrev_b32 v8, 5, v10
    v_add3_u32 v7, v7, v8, 0
    v_sub_u32 v8, 448, v7
    v_cmp_lt_u32 vcc, 224, v7
    s_nop 1
    v_cndmask_b32 v52, v7, v8, vcc
    v_cndmask_b32 v54, 0, 1, vcc
    v_cndmask_b32 v8, 1, -1, vcc
    v_add_u32 v7, s90, v57
    v_mul_i32_i24 v7, v7, v8
    v_and_b32 v7, 7, v7
    v_add_u32 v7, v7, v52
    v_lshlrev_b32 v7, 1, v7
    v_lshl_add_u32 v52, v54, 13, v7
    v_lshl_add_u32 v52, v57, 9, v52
    v_add_u32 v52, 49152, v52
    v_lshlrev_b32 v54, 31, v54
    v_bfe_u32 v7, v10, 1, 4
    v_mul_u32_u24 v7, 28, v7
    v_lshrrev_b32 v8, 5, v10
    v_add3_u32 v7, v7, v8, 8
    v_sub_u32 v8, 448, v7
    v_cmp_lt_u32 vcc, 224, v7
    s_nop 1
    v_cndmask_b32 v53, v7, v8, vcc
    v_cndmask_b32 v55, 0, 1, vcc
    v_cndmask_b32 v8, 1, -1, vcc
    v_add_u32 v7, s90, v57
    v_mul_i32_i24 v7, v7, v8
    v_and_b32 v7, 7, v7
    v_add_u32 v7, v7, v53
    v_lshlrev_b32 v7, 1, v7
    v_lshl_add_u32 v53, v55, 13, v7
    v_lshl_add_u32 v53, v57, 9, v53
    v_add_u32 v53, 49152, v53
    v_lshlrev_b32 v55, 31, v55
    v_lshrrev_b32 v59, 4, v10
    v_lshlrev_b32 v59, 2, v59
    v_lshrrev_b32 v7, 1, v10
    v_lshlrev_b32 v60, 13, v7
    v_lshl_add_u32 v60, v57, 4, v60
    v_add_u32 v61, 32768, v9
    s_lshl_b32 s84, s75, 2
    s_add_u32 s84, s84, s18
    s_mul_i32 s84, s84, 57344
    s_lshl_b32 s3, s74, 11
    s_add_u32 s84, s84, s3
    s_cmp_eq_u32 s76, 0
    s_cselect_b32 s84, 0x10000000, s84
    s_waitcnt vmcnt(3)
    s_mov_b64 exec, 1
    ds_add_rtn_u32 v7, v18, v19 offset:36
    s_mov_b64 exec, -1
    s_mov_b32 s16, 0
    s_waitcnt lgkmcnt(0)
    v_readfirstlane_b32 s3, v7
    s_nop 0
    s_cmp_ge_u32 s3, 3
    s_cbranch_scc1 LB_done7
LB_spin7:
    ds_read_b32 v7, v18 offset:36
    s_add_u32 s16, s16, 1
    s_waitcnt lgkmcnt(0)
    v_readfirstlane_b32 s3, v7
    s_cmp_ge_u32 s16, 33554432
    s_cbranch_scc1 LB_done7
    s_cmp_lt_u32 s3, 4
    s_cbranch_scc1 LB_spin7
LB_done7:
    ds_read_u16 v36, v52 offset:0
    ds_read_u16 v44, v52 offset:4096
    ds_read_u16 v37, v52 offset:1024
    ds_read_u16 v45, v52 offset:5120
    ds_read_u16 v38, v52 offset:2048
    ds_read_u16 v46, v52 offset:6144
    ds_read_u16 v39, v52 offset:3072
    ds_read_u16 v47, v52 offset:7168
    ds_read_u16 v40, v53 offset:0
    ds_read_u16 v48, v53 offset:4096
    ds_read_u16 v41, v53 offset:1024
    ds_read_u16 v49, v53 offset:5120
    ds_read_u16 v42, v53 offset:2048
    ds_read_u16 v50, v53 offset:6144
    ds_read_u16 v43, v53 offset:3072
    ds_read_u16 v51, v53 offset:7168
    v_mov_b32 v56, 0
    s_mov_b32 s3, 0x7fff7fff
    s_add_u32 s16, s88, 4096
    s_waitcnt lgkmcnt(0)
    v_lshl_or_b32 v36, v44, 16, v36
    v_and_b32 v7, s3, v36
    v_pk_max_u16 v56, v56, v7
    v_xor_b32 v36, v54, v36
    v_lshl_or_b32 v37, v45, 16, v37
    v_and_b32 v7, s3, v37
    v_pk_max_u16 v56, v56, v7
    v_xor_b32 v37, v54, v37
    v_lshl_or_b32 v38, v46, 16, v38
    v_and_b32 v7, s3, v38
    v_pk_max_u16 v56, v56, v7
    v_xor_b32 v38, v54, v38
    v_lshl_or_b32 v39, v47, 16, v39
    v_and_b32 v7, s3, v39
    v_pk_max_u16 v56, v56, v7
    v_xor_b32 v39, v54, v39
    v_lshl_or_b32 v40, v48, 16, v40
    v_and_b32 v7, s3, v40
    v_pk_max_u16 v56, v56, v7
    v_xor_b32 v40, v55, v40
    v_lshl_or_b32 v41, v49, 16, v41
    v_and_b32 v7, s3, v41
    v_pk_max_u16 v56, v56, v7
    v_xor_b32 v41, v55, v41
    v_lshl_or_b32 v42, v50, 16, v42
    v_and_b32 v7, s3, v42
    v_pk_max_u16 v56, v56, v7
    v_xor_b32 v42, v55, v42
    v_lshl_or_b32 v43, v51, 16, v43
    v_and_b32 v7, s3, v43
    v_pk_max_u16 v56, v56, v7
    v_xor_b32 v43, v55, v43
    v_lshrrev_b32 v7, 16, v56
    v_and_b32 v56, 0xffff, v56
    v_max_u32 v56, v56, v7
    s_nop 1
    v_max_u32_dpp v56, v56, v56 quad_perm:[1,0,3,2] row_mask:0xf bank_mask:0xf
    s_nop 1
    v_max_u32_dpp v56, v56, v56 quad_perm:[2,3,0,1] row_mask:0xf bank_mask:0xf
    s_nop 1
    v_max_u32_dpp v56, v56, v56 row_half_mirror row_mask:0xf bank_mask:0xf
    s_nop 1
    v_max_u32_dpp v56, v56, v56 row_mirror row_mask:0xf bank_mask:0xf
    ds_write_b32 v59, v56 offset:16384
    s_add_u32 s17, s88, 4096
    buffer_store_dwordx4 v[36:39], v9, s[24:27], s88 offen sc1
    buffer_store_dwordx4 v[40:43], v9, s[24:27], s17 offen sc1
    s_waitcnt vmcnt(2)
    s_mov_b64 exec, 1
    ds_add_u32 v18, v19 offset:4
    s_mov_b64 exec, -1
    s_add_u32 s16, s89, 114688
    buffer_load_dwordx4 v[32:35], v58, s[48:51], s16 offen
    s_add_u32 s16, s89, 143360
    buffer_load_dwordx4 v[32:35], v58, s[48:51], s16 offen
    s_add_u32 s16, s89, 172032
    buffer_load_dwordx4 v[32:35], v58, s[48:51], s16 offen
    s_add_u32 s16, s89, 200704
    buffer_load_dwordx4 v[32:35], v58, s[48:51], s16 offen
    v_bfe_u32 v7, v2, 4, 2
    v_lshlrev_b32 v7, 1, v7
    v_and_b32 v8, 7, v2
    v_xor_b32 v7, v7, v8
    v_lshlrev_b32 v12, 4, v7
    v_lshrrev_b32 v7, 3, v2
    v_lshl_add_u32 v13, v7, 12, v12
    v_bfe_u32 v7, v2, 3, 2
    v_lshlrev_b32 v7, 8, v7
    v_lshrrev_b32 v8, 5, v2
    v_add_u32 v7, v7, v8
    v_mul_u32_u24 v7, 3584, v7
    v_add_u32 v12, v12, v7
    v_lshrrev_b32 v7, 2, v2
    v_lshlrev_b32 v14, 7, v7
    v_bfe_u32 v8, v2, 3, 2
    v_lshlrev_b32 v8, 5, v8
    v_add_u32 v14, v14, v8
    v_and_b32 v8, 3, v2
    v_lshl_add_u32 v14, v8, 3, v14
    v_add_u32 v14, s85, v14
    v_xor_b32 v15, 32, v14
    v_xor_b32 v16, 64, v14
    v_xor_b32 v17, 96, v14
    s_sub_u32 s90, s85, 65536
    s_cmp_lg_u32 s72, 4
    s_cbranch_scc1 Z_nowatch
    s_mov_b32 s16, 0
LB_spin8:
    ds_read_b32 v7, v18 offset:40
    s_add_u32 s16, s16, 1
    s_waitcnt lgkmcnt(0)
    v_readfirstlane_b32 s3, v7
    s_cmp_ge_u32 s16, 33554432
    s_cbranch_scc1 LB_done8
    s_cmp_ge_u32 s3, 4
    s_cbranch_scc1 LB_done8
    s_sleep 2
    s_branch LB_spin8
LB_done8:
    v_and_b32 v8, 3, v2
    v_lshlrev_b32 v8, 6, v8
    s_mov_b32 s6, 0
    s_mov_b64 exec, 15
Z_watch:
    buffer_load_dword v7, v8, s[12:15], 0 offen sc1
    s_add_u32 s6, s6, 1
    s_waitcnt vmcnt(0)
    v_cmp_gt_u32 vcc, 64, v7
    s_cmp_ge_u32 s6, 1048576
    s_cbranch_scc1 Z_watch_done
    s_cbranch_vccz Z_watch_done
    s_sleep 16
    s_branch Z_watch
Z_watch_done:
    s_mov_b64 exec, 1
    ds_add_u32 v18, v19 offset:8
    s_mov_b64 exec, -1
Z_nowatch:
    s_mov_b32 s16, 0
LB_spin9:
    ds_read_b32 v7, v18 offset:8
    s_add_u32 s16, s16, 1
    s_waitcnt lgkmcnt(0)
    v_readfirstlane_b32 s3, v7
    s_cmp_ge_u32 s16, 33554432
    s_cbranch_scc1 LB_done9
    s_cmp_ge_u32 s3, 1
    s_cbranch_scc1 LB_done9
    s_sleep 2
    s_branch LB_spin9
LB_done9:
    s_lshl_b32 s91, s73, 5
    s_add_u32 s7, s91, 0x100000
    s_lshl_b32 s17, s18, 10
    s_mov_b32 s6, 0
Z_pollW:
    s_add_u32 m0, s17, 32768
    s_add_u32 s6, s6, 1
    buffer_load_dwordx4 v60, s[24:27], s91 offen sc1 lds
    s_add_u32 m0, s17, 36864
    s_nop 0
    buffer_load_dwordx4 v60, s[24:27], s7 offen sc1 lds
    s_waitcnt vmcnt(0)
    ds_read2_b32 v[64:65], v61 offset0:0 offset1:3
    ds_read_b32 v66, v61 offset:4096
    ds_read_b32 v67, v61 offset:4108
    s_waitcnt lgkmcnt(0)
    v_max3_u32 v7, v64, v65, v66
    v_max_u32 v7, v7, v67
    v_cmp_eq_u32 vcc, -1, v7
    s_cmp_ge_u32 s6, 1048576
    s_cbranch_scc1 Z_pollW_done
    s_and_b64 exec, exec, vcc
    s_cbranch_execnz Z_pollW
Z_pollW_done:
    s_mov_b64 exec, -1
    s_mov_b64 exec, 1
    ds_add_u32 v18, v19 offset:12
    s_mov_b64 exec, -1
    s_mov_b32 s16, 0
LB_spin10:
    ds_read_b32 v7, v18 offset:16
    s_add_u32 s16, s16, 1
    s_waitcnt lgkmcnt(0)
    v_readfirstlane_b32 s3, v7
    s_cmp_ge_u32 s16, 33554432
    s_cbranch_scc1 LB_done10
    s_cmp_ge_u32 s3, 4
    s_cbranch_scc1 LB_done10
    s_sleep 2
    s_branch LB_spin10
LB_done10:
    buffer_store_dwordx4 v[24:27], v11, s[40:43], s82 offen sc1
    buffer_store_dwordx4 v[24:27], v11, s[40:43], s83 offen sc1
    s_add_u32 m0, s85, 0
    s_add_u32 s17, s86, 0
    buffer_load_dwordx4 v12, s[48:51], s17 offen lds
    s_add_u32 m0, s85, 1024
    s_add_u32 s17, s86, 7168
    buffer_load_dwordx4 v12, s[48:51], s17 offen lds
    s_add_u32 m0, s85, 2048
    s_add_u32 s17, s86, 3670016
    buffer_load_dwordx4 v12, s[48:51], s17 offen lds
    s_add_u32 m0, s85, 3072
    s_add_u32 s17, s86, 3677184
    buffer_load_dwordx4 v12, s[48:51], s17 offen lds
    s_add_u32 m0, s85, 4096
    s_add_u32 s17, s86, 14336
    buffer_load_dwordx4 v12, s[48:51], s17 offen lds
    s_add_u32 m0, s85, 5120
    s_add_u32 s17, s86, 21504
    buffer_load_dwordx4 v12, s[48:51], s17 offen lds
    s_add_u32 m0, s85, 6144
    s_add_u32 s17, s86, 3684352
    buffer_load_dwordx4 v12, s[48:51], s17 offen lds
    s_add_u32 m0, s85, 7168
    s_add_u32 s17, s86, 3691520
    buffer_load_dwordx4 v12, s[48:51], s17 offen lds
    s_add_u32 m0, s85, 8192
    s_add_u32 s17, s86, 28672
    buffer_load_dwordx4 v12, s[48:51], s17 offen lds
    s_add_u32 m0, s85, 9216
    s_add_u32 s17, s86, 35840
    buffer_load_dwordx4 v12, s[48:51], s17 offen lds
    s_add_u32 m0, s85, 10240
    s_add_u32 s17, s86, 3698688
    buffer_load_dwordx4 v12, s[48:51], s17 offen lds
    s_add_u32 m0, s85, 11264
    s_add_u32 s17, s86, 3705856
    buffer_load_dwordx4 v12, s[48:51], s17 offen lds
    s_add_u32 m0, s85, 12288
    s_add_u32 s17, s86, 43008
    buffer_load_dwordx4 v12, s[48:51], s17 offen lds
    s_add_u32 m0, s85, 13312
    s_add_u32 s17, s86, 50176
    buffer_load_dwordx4 v12, s[48:51], s17 offen lds
    s_add_u32 m0, s85, 14336
    s_add_u32 s17, s86, 3713024
    buffer_load_dwordx4 v12, s[48:51], s17 offen lds
    s_add_u32 m0, s85, 15360
    s_add_u32 s17, s86, 3720192
    buffer_load_dwordx4 v12, s[48:51], s17 offen lds
    s_waitcnt vmcnt(16)
    s_mov_b64 exec, 1
    ds_add_u32 v18, v19 offset:20
    s_mov_b64 exec, -1
    s_waitcnt vmcnt(12)
    ds_read_b64_tr_b16 a[0:1], v14 offset:0
    ds_read_b64_tr_b16 a[2:3], v14 offset:2048
    ds_read_b64_tr_b16 a[4:5], v15 offset:0
    ds_read_b64_tr_b16 a[6:7], v15 offset:2048
    ds_read_b64_tr_b16 a[8:9], v16 offset:0
    ds_read_b64_tr_b16 a[10:11], v16 offset:2048
    ds_read_b64_tr_b16 a[12:13], v17 offset:0
    ds_read_b64_tr_b16 a[14:15], v17 offset:2048
    s_waitcnt vmcnt(8)
    ds_read_b64_tr_b16 a[16:17], v14 offset:4096
    ds_read_b64_tr_b16 a[18:19], v14 offset:6144
    ds_read_b64_tr_b16 a[20:21], v15 offset:4096
    ds_read_b64_tr_b16 a[22:23], v15 offset:6144
    ds_read_b64_tr_b16 a[24:25], v16 offset:4096
    ds_read_b64_tr_b16 a[26:27], v16 offset:6144
    ds_read_b64_tr_b16 a[28:29], v17 offset:4096
    ds_read_b64_tr_b16 a[30:31], v17 offset:6144
    s_waitcnt vmcnt(4)
    ds_read_b64_tr_b16 a[32:33], v14 offset:8192
    ds_read_b64_tr_b16 a[34:35], v14 offset:10240
    ds_read_b64_tr_b16 a[36:37], v15 offset:8192
    ds_read_b64_tr_b16 a[38:39], v15 offset:10240
    ds_read_b64_tr_b16 a[40:41], v16 offset:8192
    ds_read_b64_tr_b16 a[42:43], v16 offset:10240
    ds_read_b64_tr_b16 a[44:45], v17 offset:8192
    ds_read_b64_tr_b16 a[46:47], v17 offset:10240
    s_waitcnt vmcnt(0)
    ds_read_b64_tr_b16 a[48:49], v14 offset:12288
    ds_read_b64_tr_b16 a[50:51], v14 offset:14336
    ds_read_b64_tr_b16 a[52:53], v15 offset:12288
    ds_read_b64_tr_b16 a[54:55], v15 offset:14336
    ds_read_b64_tr_b16 a[56:57], v16 offset:12288
    ds_read_b64_tr_b16 a[58:59], v16 offset:14336
    ds_read_b64_tr_b16 a[60:61], v17 offset:12288
    ds_read_b64_tr_b16 a[62:63], v17 offset:14336
    s_mov_b32 s16, 0
LB_spin11:
    ds_read_b32 v7, v18 offset:44
    s_add_u32 s16, s16, 1
    s_waitcnt lgkmcnt(0)
    v_readfirstlane_b32 s3, v7
    s_cmp_ge_u32 s16, 33554432
    s_cbranch_scc1 LB_done11
    s_cmp_ge_u32 s3, 4
    s_cbranch_scc1 LB_done11
    s_sleep 2
    s_branch LB_spin11
LB_done11:
    s_waitcnt lgkmcnt(0)
    s_add_u32 m0, s85, 0
    s_add_u32 s17, s86, 57344
    buffer_load_dwordx4 v12, s[48:51], s17 offen lds
    s_add_u32 m0, s85, 1024
    s_add_u32 s17, s86, 64512
    buffer_load_dwordx4 v12, s[48:51], s17 offen lds
    s_add_u32 m0, s85, 2048
    s_add_u32 s17, s86, 3727360
    buffer_load_dwordx4 v12, s[48:51], s17 offen lds
    s_add_u32 m0, s85, 3072
    s_add_u32 s17, s86, 3734528
    buffer_load_dwordx4 v12, s[48:51], s17 offen lds
    s_add_u32 m0, s85, 4096
    s_add_u32 s17, s86, 71680
    buffer_load_dwordx4 v12, s[48:51], s17 offen lds
    s_add_u32 m0, s85, 5120
    s_add_u32 s17, s86, 78848
    buffer_load_dwordx4 v12, s[48:51], s17 offen lds
    s_add_u32 m0, s85, 6144
    s_add_u32 s17, s86, 3741696
    buffer_load_dwordx4 v12, s[48:51], s17 offen lds
    s_add_u32 m0, s85, 7168
    s_add_u32 s17, s86, 3748864
    buffer_load_dwordx4 v12, s[48:51], s17 offen lds
    s_add_u32 m0, s85, 8192
    s_add_u32 s17, s86, 86016
    buffer_load_dwordx4 v12, s[48:51], s17 offen lds
    s_add_u32 m0, s85, 9216
    s_add_u32 s17, s86, 93184
    buffer_load_dwordx4 v12, s[48:51], s17 offen lds
    s_add_u32 m0, s85, 10240
    s_add_u32 s17, s86, 3756032
    buffer_load_dwordx4 v12, s[48:51], s17 offen lds
    s_add_u32 m0, s85, 11264
    s_add_u32 s17, s86, 3763200
    buffer_load_dwordx4 v12, s[48:51], s17 offen lds
    s_add_u32 m0, s85, 12288
    s_add_u32 s17, s86, 100352
    buffer_load_dwordx4 v12, s[48:51], s17 offen lds
    s_add_u32 m0, s85, 13312
    s_add_u32 s17, s86, 107520
    buffer_load_dwordx4 v12, s[48:51], s17 offen lds
    s_add_u32 m0, s85, 14336
    s_add_u32 s17, s86, 3770368
    buffer_load_dwordx4 v12, s[48:51], s17 offen lds
    s_add_u32 m0, s85, 15360
    s_add_u32 s17, s86, 3777536
    buffer_load_dwordx4 v12, s[48:51], s17 offen lds
    s_add_u32 s16, s89, 0
    buffer_load_dwordx4 v[32:35], v58, s[48:51], s16 offen
    s_add_u32 s16, s89, 28672
    buffer_load_dwordx4 v[32:35], v58, s[48:51], s16 offen
    s_add_u32 s16, s89, 57344
    buffer_load_dwordx4 v[32:35], v58, s[48:51], s16 offen
    s_add_u32 s16, s89, 86016
    buffer_load_dwordx4 v[32:35], v58, s[48:51], s16 offen
    s_waitcnt vmcnt(16)
    ds_read_b64_tr_b16 a[64:65], v14 offset:0
    ds_read_b64_tr_b16 a[66:67], v14 offset:2048
    ds_read_b64_tr_b16 a[68:69], v15 offset:0
    ds_read_b64_tr_b16 a[70:71], v15 offset:2048
    ds_read_b64_tr_b16 a[72:73], v16 offset:0
    ds_read_b64_tr_b16 a[74:75], v16 offset:2048
    ds_read_b64_tr_b16 a[76:77], v17 offset:0
    ds_read_b64_tr_b16 a[78:79], v17 offset:2048
    s_waitcnt vmcnt(12)
    ds_read_b64_tr_b16 a[80:81], v14 offset:4096
    ds_read_b64_tr_b16 a[82:83], v14 offset:6144
    ds_read_b64_tr_b16 a[84:85], v15 offset:4096
    ds_read_b64_tr_b16 a[86:87], v15 offset:6144
    ds_read_b64_tr_b16 a[88:89], v16 offset:4096
    ds_read_b64_tr_b16 a[90:91], v16 offset:6144
    ds_read_b64_tr_b16 a[92:93], v17 offset:4096
    ds_read_b64_tr_b16 a[94:95], v17 offset:6144
    s_waitcnt vmcnt(8)
    ds_read_b64_tr_b16 a[96:97], v14 offset:8192
    ds_read_b64_tr_b16 a[98:99], v14 offset:10240
    ds_read_b64_tr_b16 a[100:101], v15 offset:8192
    ds_read_b64_tr_b16 a[102:103], v15 offset:10240
    ds_read_b64_tr_b16 a[104:105], v16 offset:8192
    ds_read_b64_tr_b16 a[106:107], v16 offset:10240
    ds_read_b64_tr_b16 a[108:109], v17 offset:8192
    ds_read_b64_tr_b16 a[110:111], v17 offset:10240
    s_waitcnt vmcnt(4)
    ds_read_b64_tr_b16 a[112:113], v14 offset:12288
    ds_read_b64_tr_b16 a[114:115], v14 offset:14336
    ds_read_b64_tr_b16 a[116:117], v15 offset:12288
    ds_read_b64_tr_b16 a[118:119], v15 offset:14336
    ds_read_b64_tr_b16 a[120:121], v16 offset:12288
    ds_read_b64_tr_b16 a[122:123], v16 offset:14336
    ds_read_b64_tr_b16 a[124:125], v17 offset:12288
    ds_read_b64_tr_b16 a[126:127], v17 offset:14336
    s_mov_b32 s16, 0
LB_spin12:
    ds_read_b32 v7, v18 offset:24
    s_add_u32 s16, s16, 1
    s_waitcnt lgkmcnt(0)
    v_readfirstlane_b32 s3, v7
    s_cmp_ge_u32 s16, 33554432
    s_cbranch_scc1 LB_done12
    s_cmp_ge_u32 s3, 4
    s_cbranch_scc1 LB_done12
    s_sleep 2
    s_branch LB_spin12
LB_done12:
    buffer_store_dwordx4 v[24:27], v3, s[44:47], s84 offen sc1
    buffer_store_dwordx4 v[24:27], v3, s[44:47], s84 offen offset:1024 sc1
    s_waitcnt vmcnt(0)
    s_mov_b64 exec, 1
    ds_add_u32 v18, v19 offset:28
    s_mov_b64 exec, -1
    s_add_u32 m0, s90, 0
    s_add_u32 s17, s86, 4294852608
    buffer_load_dwordx4 v12, s[48:51], s17 offen lds
    s_add_u32 m0, s90, 1024
    s_add_u32 s17, s86, 4294859776
    buffer_load_dwordx4 v12, s[48:51], s17 offen lds
    s_add_u32 m0, s90, 2048
    s_add_u32 s17, s86, 3555328
    buffer_load_dwordx4 v12, s[48:51], s17 offen lds
    s_add_u32 m0, s90, 3072
    s_add_u32 s17, s86, 3562496
    buffer_load_dwordx4 v12, s[48:51], s17 offen lds
    s_add_u32 m0, s90, 4096
    s_add_u32 s17, s86, 4294866944
    buffer_load_dwordx4 v12, s[48:51], s17 offen lds
    s_add_u32 m0, s90, 5120
    s_add_u32 s17, s86, 4294874112
    buffer_load_dwordx4 v12, s[48:51], s17 offen lds
    s_add_u32 m0, s90, 6144
    s_add_u32 s17, s86, 3569664
    buffer_load_dwordx4 v12, s[48:51], s17 offen lds
    s_add_u32 m0, s90, 7168
    s_add_u32 s17, s86, 3576832
    buffer_load_dwordx4 v12, s[48:51], s17 offen lds
    s_add_u32 m0, s90, 8192
    s_add_u32 s17, s86, 4294881280
    buffer_load_dwordx4 v12, s[48:51], s17 offen lds
    s_add_u32 m0, s90, 9216
    s_add_u32 s17, s86, 4294888448
    buffer_load_dwordx4 v12, s[48:51], s17 offen lds
    s_add_u32 m0, s90, 10240
    s_add_u32 s17, s86, 3584000
    buffer_load_dwordx4 v12, s[48:51], s17 offen lds
    s_add_u32 m0, s90, 11264
    s_add_u32 s17, s86, 3591168
    buffer_load_dwordx4 v12, s[48:51], s17 offen lds
    s_add_u32 m0, s90, 12288
    s_add_u32 s17, s86, 4294895616
    buffer_load_dwordx4 v12, s[48:51], s17 offen lds
    s_add_u32 m0, s90, 13312
    s_add_u32 s17, s86, 4294902784
    buffer_load_dwordx4 v12, s[48:51], s17 offen lds
    s_add_u32 m0, s90, 14336
    s_add_u32 s17, s86, 3598336
    buffer_load_dwordx4 v12, s[48:51], s17 offen lds
    s_add_u32 m0, s90, 15360
    s_add_u32 s17, s86, 3605504
    buffer_load_dwordx4 v12, s[48:51], s17 offen lds
    s_mov_b32 s16, 0
LB_spin13:
    ds_read_b32 v7, v18 offset:52
    s_add_u32 s16, s16, 1
    s_waitcnt lgkmcnt(0)
    v_readfirstlane_b32 s3, v7
    s_cmp_ge_u32 s16, 33554432
    s_cbranch_scc1 LB_done13
    s_cmp_ge_u32 s3, 4
    s_cbranch_scc1 LB_done13
    s_sleep 2
    s_branch LB_spin13
LB_done13:
    s_waitcnt lgkmcnt(0)
    s_add_u32 m0, s85, 0
    s_add_u32 s17, s86, 4294909952
    buffer_load_dwordx4 v12, s[48:51], s17 offen lds
    s_add_u32 m0, s85, 1024
    s_add_u32 s17, s86, 4294917120
    buffer_load_dwordx4 v12, s[48:51], s17 offen lds
    s_add_u32 m0, s85, 2048
    s_add_u32 s17, s86, 3612672
    buffer_load_dwordx4 v12, s[48:51], s17 offen lds
    s_add_u32 m0, s85, 3072
    s_add_u32 s17, s86, 3619840
    buffer_load_dwordx4 v12, s[48:51], s17 offen lds
    s_add_u32 m0, s85, 4096
    s_add_u32 s17, s86, 4294924288
    buffer_load_dwordx4 v12, s[48:51], s17 offen lds
    s_add_u32 m0, s85, 5120
    s_add_u32 s17, s86, 4294931456
    buffer_load_dwordx4 v12, s[48:51], s17 offen lds
    s_add_u32 m0, s85, 6144
    s_add_u32 s17, s86, 3627008
    buffer_load_dwordx4 v12, s[48:51], s17 offen lds
    s_add_u32 m0, s85, 7168
    s_add_u32 s17, s86, 3634176
    buffer_load_dwordx4 v12, s[48:51], s17 offen lds
    s_add_u32 m0, s85, 8192
    s_add_u32 s17, s86, 4294938624
    buffer_load_dwordx4 v12, s[48:51], s17 offen lds
    s_add_u32 m0, s85, 9216
    s_add_u32 s17, s86, 4294945792
    buffer_load_dwordx4 v12, s[48:51], s17 offen lds
    s_add_u32 m0, s85, 10240
    s_add_u32 s17, s86, 3641344
    buffer_load_dwordx4 v12, s[48:51], s17 offen lds
    s_add_u32 m0, s85, 11264
    s_add_u32 s17, s86, 3648512
    buffer_load_dwordx4 v12, s[48:51], s17 offen lds
    s_add_u32 m0, s85, 12288
    s_add_u32 s17, s86, 4294952960
    buffer_load_dwordx4 v12, s[48:51], s17 offen lds
    s_add_u32 m0, s85, 13312
    s_add_u32 s17, s86, 4294960128
    buffer_load_dwordx4 v12, s[48:51], s17 offen lds
    s_add_u32 m0, s85, 14336
    s_add_u32 s17, s86, 3655680
    buffer_load_dwordx4 v12, s[48:51], s17 offen lds
    s_add_u32 m0, s85, 15360
    s_add_u32 s17, s86, 3662848
    buffer_load_dwordx4 v12, s[48:51], s17 offen lds
    s_waitcnt vmcnt(0)
    s_waitcnt lgkmcnt(0)
    s_barrier
Z_join:
    v_add_u32 v9, s85, v3
    s_lshl_b32 s89, s18, 12
    s_cmp_ge_u32 s72, 4
    s_cselect_b32 s16, 147456, 0
    s_add_u32 s89, s89, s16
    s_cmp_eq_u32 s76, 0
    s_cbranch_scc1 Z_idle1
    s_lshl_b32 s88, s75, 18
    s_lshl_b32 s3, s19, 13
    s_add_u32 s88, s88, s3
    v_and_b32 v7, 31, v2
    v_lshlrev_b32 v8, 8, v7
    v_lshrrev_b32 v7, 5, v2
    v_mul_u32_u24 v7, 196608, v7
    v_add_u32 v8, v8, v7
    s_and_b32 s3, s72, 1
    s_lshl_b32 s16, s72, 11
    s_add_u32 s16, s16, 16384
    v_add_u32 v11, s16, v3
    s_lshl_b32 s16, s74, 7
    s_lshl_b32 s17, s3, 6
    s_add_u32 s16, s16, s17
    v_lshlrev_b32 v7, 3, v5
    buffer_load_dwordx2 v[116:117], v7, s[56:59], s16 offen
    buffer_load_dwordx2 v[118:119], v7, s[56:59], s16 offen offset:32
    s_lshr_b32 s16, s72, 1
    s_lshl_b32 s84, s75, 2
    s_add_u32 s84, s84, s16
    s_mul_i32 s84, s84, 57344
    s_lshl_b32 s16, s74, 1
    s_add_u32 s16, s16, s3
    s_lshl_b32 s16, s16, 10
    s_add_u32 s84, s84, s16
    s_mov_b32 s6, 0
D_probe:
    buffer_load_dword v7, v8, s[40:43], s88 offen sc1
    s_add_u32 s6, s6, 1
    s_waitcnt vmcnt(0)
    v_cmp_eq_u32 vcc, -1, v7
    s_cmp_ge_u32 s6, 1048576
    s_cbranch_scc1 D_probe_done
    s_and_b64 exec, exec, vcc
    s_cbranch_execnz D_probe
D_probe_done:
    s_mov_b64 exec, -1
    s_add_u32 s7, s88, 0
    buffer_load_dwordx4 v[20:23], v3, s[40:43], s7 offen sc1
    s_add_u32 s7, s88, 1024
    buffer_load_dwordx4 v[24:27], v3, s[40:43], s7 offen sc1
    s_add_u32 s7, s88, 2048
    buffer_load_dwordx4 v[28:31], v3, s[40:43], s7 offen sc1
    s_add_u32 s7, s88, 3072
    buffer_load_dwordx4 v[32:35], v3, s[40:43], s7 offen sc1
    s_add_u32 s7, s88, 4096
    buffer_load_dwordx4 v[36:39], v3, s[40:43], s7 offen sc1
    s_add_u32 s7, s88, 5120
    buffer_load_dwordx4 v[40:43], v3, s[40:43], s7 offen sc1
    s_waitcnt vmcnt(5)
D_chk0:
    v_max_u32 v7, v20, v23
    v_cmp_eq_u32 vcc, -1, v7
    s_cbranch_vccnz D_retry0
D_go0:
    v_mfma_f32_16x16x32_bf16 v[84:87], a[0:3], v[20:23], 0
    v_mfma_f32_16x16x32_bf16 v[88:91], a[4:7], v[20:23], 0
    v_mfma_f32_16x16x32_bf16 v[92:95], a[8:11], v[20:23], 0
    v_mfma_f32_16x16x32_bf16 v[96:99], a[12:15], v[20:23], 0
    s_add_u32 s7, s88, 6144
    buffer_load_dwordx4 v[20:23], v3, s[40:43], s7 offen sc1
    s_barrier
    s_waitcnt vmcnt(5)
D_chk1:
    v_max_u32 v7, v24, v27
    v_cmp_eq_u32 vcc, -1, v7
    s_cbranch_vccnz D_retry1
D_go1:
    v_mfma_f32_16x16x32_bf16 v[84:87], a[16:19], v[24:27], v[84:87]
    v_mfma_f32_16x16x32_bf16 v[88:91], a[20:23], v[24:27], v[88:91]
    v_mfma_f32_16x16x32_bf16 v[92:95], a[24:27], v[24:27], v[92:95]
    v_mfma_f32_16x16x32_bf16 v[96:99], a[28:31], v[24:27], v[96:99]
    s_add_u32 s7, s88, 7168
    buffer_load_dwordx4 v[24:27], v3, s[40:43], s7 offen sc1
    s_waitcnt vmcnt(5)
D_chk2:
    v_max_u32 v7, v28, v31
    v_cmp_eq_u32 vcc, -1, v7
    s_cbranch_vccnz D_retry2
D_go2:
    v_mfma_f32_16x16x32_bf16 v[84:87], a[32:35], v[28:31], v[84:87]
    v_mfma_f32_16x16x32_bf16 v[88:91], a[36:39], v[28:31], v[88:91]
    v_mfma_f32_16x16x32_bf16 v[92:95], a[40:43], v[28:31], v[92:95]
    v_mfma_f32_16x16x32_bf16 v[96:99], a[44:47], v[28:31], v[96:99]
    s_add_u32 s7, s88, 65536
    buffer_load_dwordx4 v[28:31], v3, s[40:43], s7 offen sc1
    s_waitcnt vmcnt(5)
D_chk3:
    v_max_u32 v7, v32, v35
    v_cmp_eq_u32 vcc, -1, v7
    s_cbranch_vccnz D_retry3
D_go3:
    v_mfma_f32_16x16x32_bf16 v[84:87], a[48:51], v[32:35], v[84:87]
    v_mfma_f32_16x16x32_bf16 v[88:91], a[52:55], v[32:35], v[88:91]
    v_mfma_f32_16x16x32_bf16 v[92:95], a[56:59], v[32:35], v[92:95]
    v_mfma_f32_16x16x32_bf16 v[96:99], a[60:63], v[32:35], v[96:99]
    s_add_u32 s7, s88, 66560
    buffer_load_dwordx4 v[32:35], v3, s[40:43], s7 offen sc1
    s_waitcnt vmcnt(5)
D_chk4:
    v_max_u32 v7, v36, v39
    v_cmp_eq_u32 vcc, -1, v7
    s_cbranch_vccnz D_retry4
D_go4:
    v_mfma_f32_16x16x32_bf16 v[84:87], a[64:67], v[36:39], v[84:87]
    v_mfma_f32_16x16x32_bf16 v[88:91], a[68:71], v[36:39], v[88:91]
    v_mfma_f32_16x16x32_bf16 v[92:95], a[72:75], v[36:39], v[92:95]
    v_mfma_f32_16x16x32_bf16 v[96:99], a[76:79], v[36:39], v[96:99]
    s_add_u32 s7, s88, 67584
    buffer_load_dwordx4 v[36:39], v3, s[40:43], s7 offen sc1
    s_waitcnt vmcnt(5)
D_chk5:
    v_max_u32 v7, v40, v43
    v_cmp_eq_u32 vcc, -1, v7
    s_cbranch_vccnz D_retry5
D_go5:
    v_mfma_f32_16x16x32_bf16 v[84:87], a[80:83], v[40:43], v[84:87]
    v_mfma_f32_16x16x32_bf16 v[88:91], a[84:87], v[40:43], v[88:91]
    v_mfma_f32_16x16x32_bf16 v[92:95], a[88:91], v[40:43], v[92:95]
    v_mfma_f32_16x16x32_bf16 v[96:99], a[92:95], v[40:43], v[96:99]
    s_add_u32 s7, s88, 68608
    buffer_load_dwordx4 v[40:43], v3, s[40:43], s7 offen sc1
    s_waitcnt vmcnt(5)
D_chk6:
    v_max_u32 v7, v20, v23
    v_cmp_eq_u32 vcc, -1, v7
    s_cbranch_vccnz D_retry6
D_go6:
    v_mfma_f32_16x16x32_bf16 v[84:87], a[96:99], v[20:23], v[84:87]
    v_mfma_f32_16x16x32_bf16 v[88:91], a[100:103], v[20:23], v[88:91]
    v_mfma_f32_16x16x32_bf16 v[92:95], a[104:107], v[20:23], v[92:95]
    v_mfma_f32_16x16x32_bf16 v[96:99], a[108:111], v[20:23], v[96:99]
    s_add_u32 s7, s88, 69632
    buffer_load_dwordx4 v[20:23], v3, s[40:43], s7 offen sc1
    s_waitcnt vmcnt(5)
D_chk7:
    v_max_u32 v7, v24, v27
    v_cmp_eq_u32 vcc, -1, v7
    s_cbranch_vccnz D_retry7
D_go7:
    v_mfma_f32_16x16x32_bf16 v[84:87], a[112:115], v[24:27], v[84:87]
    v_mfma_f32_16x16x32_bf16 v[88:91], a[116:119], v[24:27], v[88:91]
    v_mfma_f32_16x16x32_bf16 v[92:95], a[120:123], v[24:27], v[92:95]
    v_mfma_f32_16x16x32_bf16 v[96:99], a[124:127], v[24:27], v[96:99]
    s_add_u32 s7, s88, 70656
    buffer_load_dwordx4 v[24:27], v3, s[40:43], s7 offen sc1
    s_waitcnt vmcnt(5)
D_chk8:
    v_max_u32 v7, v28, v31
    v_cmp_eq_u32 vcc, -1, v7
    s_cbranch_vccnz D_retry8
D_go8:
    v_mfma_f32_16x16x32_bf16 v[100:103], a[0:3], v[28:31], 0
    v_mfma_f32_16x16x32_bf16 v[104:107], a[4:7], v[28:31], 0
    v_mfma_f32_16x16x32_bf16 v[108:111], a[8:11], v[28:31], 0
    v_mfma_f32_16x16x32_bf16 v[112:115], a[12:15], v[28:31], 0
    s_add_u32 s7, s88, 71680
    buffer_load_dwordx4 v[28:31], v3, s[40:43], s7 offen sc1
    s_waitcnt vmcnt(5)
D_chk9:
    v_max_u32 v7, v32, v35
    v_cmp_eq_u32 vcc, -1, v7
    s_cbranch_vccnz D_retry9
D_go9:
    v_mfma_f32_16x16x32_bf16 v[100:103], a[16:19], v[32:35], v[100:103]
    v_mfma_f32_16x16x32_bf16 v[104:107], a[20:23], v[32:35], v[104:107]
    v_mfma_f32_16x16x32_bf16 v[108:111], a[24:27], v[32:35], v[108:111]
    v_mfma_f32_16x16x32_bf16 v[112:115], a[28:31], v[32:35], v[112:115]
    s_add_u32 s7, s88, 72704
    buffer_load_dwordx4 v[32:35], v3, s[40:43], s7 offen sc1
    ds_write_b128 v9, v[84:87] offset:0
    ds_write_b128 v9, v[88:91] offset:1024
    ds_write_b128 v9, v[92:95] offset:2048
    ds_write_b128 v9, v[96:99] offset:3072
    s_waitcnt vmcnt(5)
D_chk10:
    v_max_u32 v7, v36, v39
    v_cmp_eq_u32 vcc, -1, v7
    s_cbranch_vccnz D_retry10
D_go10:
    v_mfma_f32_16x16x32_bf16 v[100:103], a[32:35], v[36:39], v[100:103]
    v_mfma_f32_16x16x32_bf16 v[104:107], a[36:39], v[36:39], v[104:107]
    v_mfma_f32_16x16x32_bf16 v[108:111], a[40:43], v[36:39], v[108:111]
    v_mfma_f32_16x16x32_bf16 v[112:115], a[44:47], v[36:39], v[112:115]
    s_add_u32 s7, s88, 131072
    buffer_load_dwordx4 v[36:39], v3, s[40:43], s7 offen sc1
    s_waitcnt vmcnt(5)
D_chk11:
    v_max_u32 v7, v40, v43
    v_cmp_eq_u32 vcc, -1, v7
    s_cbranch_vccnz D_retry11
D_go11:
    v_mfma_f32_16x16x32_bf16 v[100:103], a[48:51], v[40:43], v[100:103]
    v_mfma_f32_16x16x32_bf16 v[104:107], a[52:55], v[40:43], v[104:107]
    v_mfma_f32_16x16x32_bf16 v[108:111], a[56:59], v[40:43], v[108:111]
    v_mfma_f32_16x16x32_bf16 v[112:115], a[60:63], v[40:43], v[112:115]
    s_add_u32 s7, s88, 132096
    buffer_load_dwordx4 v[40:43], v3, s[40:43], s7 offen sc1
    s_waitcnt vmcnt(5)
D_chk12:
    v_max_u32 v7, v20, v23
    v_cmp_eq_u32 vcc, -1, v7
    s_cbranch_vccnz D_retry12
D_go12:
    v_mfma_f32_16x16x32_bf16 v[100:103], a[64:67], v[20:23], v[100:103]
    v_mfma_f32_16x16x32_bf16 v[104:107], a[68:71], v[20:23], v[104:107]
    v_mfma_f32_16x16x32_bf16 v[108:111], a[72:75], v[20:23], v[108:111]
    v_mfma_f32_16x16x32_bf16 v[112:115], a[76:79], v[20:23], v[112:115]
    s_add_u32 s7, s88, 133120
    buffer_load_dwordx4 v[20:23], v3, s[40:43], s7 offen sc1
    s_waitcnt vmcnt(5)
D_chk13:
    v_max_u32 v7, v24, v27
    v_cmp_eq_u32 vcc, -1, v7
    s_cbranch_vccnz D_retry13
D_go13:
    v_mfma_f32_16x16x32_bf16 v[100:103], a[80:83], v[24:27], v[100:103]
    v_mfma_f32_16x16x32_bf16 v[104:107], a[84:87], v[24:27], v[104:107]
    v_mfma_f32_16x16x32_bf16 v[108:111], a[88:91], v[24:27], v[108:111]
    v_mfma_f32_16x16x32_bf16 v[112:115], a[92:95], v[24:27], v[112:115]
    s_add_u32 s7, s88, 134144
    buffer_load_dwordx4 v[24:27], v3, s[40:43], s7 offen sc1
    s_waitcnt vmcnt(5)
D_chk14:
    v_max_u32 v7, v28, v31
    v_cmp_eq_u32 vcc, -1, v7
    s_cbranch_vccnz D_retry14
D_go14:
    v_mfma_f32_16x16x32_bf16 v[100:103], a[96:99], v[28:31], v[100:103]
    v_mfma_f32_16x16x32_bf16 v[104:107], a[100:103], v[28:31], v[104:107]
    v_mfma_f32_16x16x32_bf16 v[108:111], a[104:107], v[28:31], v[108:111]
    v_mfma_f32_16x16x32_bf16 v[112:115], a[108:111], v[28:31], v[112:115]
    s_add_u32 s7, s88, 135168
    buffer_load_dwordx4 v[28:31], v3, s[40:43], s7 offen sc1
    s_waitcnt vmcnt(5)
D_chk15:
    v_max_u32 v7, v32, v35
    v_cmp_eq_u32 vcc, -1, v7
    s_cbranch_vccnz D_retry15
D_go15:
    v_mfma_f32_16x16x32_bf16 v[100:103], a[112:115], v[32:35], v[100:103]
    v_mfma_f32_16x16x32_bf16 v[104:107], a[116:119], v[32:35], v[104:107]
    v_mfma_f32_16x16x32_bf16 v[108:111], a[120:123], v[32:35], v[108:111]
    v_mfma_f32_16x16x32_bf16 v[112:115], a[124:127], v[32:35], v[112:115]
    s_add_u32 s7, s88, 136192
    buffer_load_dwordx4 v[32:35], v3, s[40:43], s7 offen sc1
    s_waitcnt lgkmcnt(0)
    s_waitcnt vmcnt(5)
D_chk16:
    v_max_u32 v7, v36, v39
    v_cmp_eq_u32 vcc, -1, v7
    s_cbranch_vccnz D_retry16
D_go16:
    v_mfma_f32_16x16x32_bf16 v[84:87], a[0:3], v[36:39], 0
    v_mfma_f32_16x16x32_bf16 v[88:91], a[4:7], v[36:39], 0
    v_mfma_f32_16x16x32_bf16 v[92:95], a[8:11], v[36:39], 0
    v_mfma_f32_16x16x32_bf16 v[96:99], a[12:15], v[36:39], 0
    s_add_u32 s7, s88, 137216
    buffer_load_dwordx4 v[36:39], v3, s[40:43], s7 offen sc1
    s_waitcnt vmcnt(5)
D_chk17:
    v_max_u32 v7, v40, v43
    v_cmp_eq_u32 vcc, -1, v7
    s_cbranch_vccnz D_retry17
D_go17:
    v_mfma_f32_16x16x32_bf16 v[84:87], a[16:19], v[40:43], v[84:87]
    v_mfma_f32_16x16x32_bf16 v[88:91], a[20:23], v[40:43], v[88:91]
    v_mfma_f32_16x16x32_bf16 v[92:95], a[24:27], v[40:43], v[92:95]
    v_mfma_f32_16x16x32_bf16 v[96:99], a[28:31], v[40:43], v[96:99]
    s_add_u32 s7, s88, 138240
    buffer_load_dwordx4 v[40:43], v3, s[40:43], s7 offen sc1
    ds_write_b128 v9, v[100:103] offset:4096
    ds_write_b128 v9, v[104:107] offset:5120
    ds_write_b128 v9, v[108:111] offset:6144
    ds_write_b128 v9, v[112:115] offset:7168
    s_waitcnt vmcnt(5)
D_chk18:
    v_max_u32 v7, v20, v23
    v_cmp_eq_u32 vcc, -1, v7
    s_cbranch_vccnz D_retry18
D_go18:
    v_mfma_f32_16x16x32_bf16 v[84:87], a[32:35], v[20:23], v[84:87]
    v_mfma_f32_16x16x32_bf16 v[88:91], a[36:39], v[20:23], v[88:91]
    v_mfma_f32_16x16x32_bf16 v[92:95], a[40:43], v[20:23], v[92:95]
    v_mfma_f32_16x16x32_bf16 v[96:99], a[44:47], v[20:23], v[96:99]
    s_add_u32 s7, s88, 196608
    buffer_load_dwordx4 v[20:23], v3, s[40:43], s7 offen sc1
    s_waitcnt vmcnt(5)
D_chk19:
    v_max_u32 v7, v24, v27
    v_cmp_eq_u32 vcc, -1, v7
    s_cbranch_vccnz D_retry19
D_go19:
    v_mfma_f32_16x16x32_bf16 v[84:87], a[48:51], v[24:27], v[84:87]
    v_mfma_f32_16x16x32_bf16 v[88:91], a[52:55], v[24:27], v[88:91]
    v_mfma_f32_16x16x32_bf16 v[92:95], a[56:59], v[24:27], v[92:95]
    v_mfma_f32_16x16x32_bf16 v[96:99], a[60:63], v[24:27], v[96:99]
    s_add_u32 s7, s88, 197632
    buffer_load_dwordx4 v[24:27], v3, s[40:43], s7 offen sc1
    s_waitcnt vmcnt(5)
D_chk20:
    v_max_u32 v7, v28, v31
    v_cmp_eq_u32 vcc, -1, v7
    s_cbranch_vccnz D_retry20
D_go20:
    v_mfma_f32_16x16x32_bf16 v[84:87], a[64:67], v[28:31], v[84:87]
    v_mfma_f32_16x16x32_bf16 v[88:91], a[68:71], v[28:31], v[88:91]
    v_mfma_f32_16x16x32_bf16 v[92:95], a[72:75], v[28:31], v[92:95]
    v_mfma_f32_16x16x32_bf16 v[96:99], a[76:79], v[28:31], v[96:99]
    s_add_u32 s7, s88, 198656
    buffer_load_dwordx4 v[28:31], v3, s[40:43], s7 offen sc1
    s_waitcnt vmcnt(5)
D_chk21:
    v_max_u32 v7, v32, v35
    v_cmp_eq_u32 vcc, -1, v7
    s_cbranch_vccnz D_retry21
D_go21:
    v_mfma_f32_16x16x32_bf16 v[84:87], a[80:83], v[32:35], v[84:87]
    v_mfma_f32_16x16x32_bf16 v[88:91], a[84:87], v[32:35], v[88:91]
    v_mfma_f32_16x16x32_bf16 v[92:95], a[88:91], v[32:35], v[92:95]
    v_mfma_f32_16x16x32_bf16 v[96:99], a[92:95], v[32:35], v[96:99]
    s_add_u32 s7, s88, 199680
    buffer_load_dwordx4 v[32:35], v3, s[40:43], s7 offen sc1
    s_waitcnt vmcnt(5)
D_chk22:
    v_max_u32 v7, v36, v39
    v_cmp_eq_u32 vcc, -1, v7
    s_cbranch_vccnz D_retry22
D_go22:
    v_mfma_f32_16x16x32_bf16 v[84:87], a[96:99], v[36:39], v[84:87]
    v_mfma_f32_16x16x32_bf16 v[88:91], a[100:103], v[36:39], v[88:91]
    v_mfma_f32_16x16x32_bf16 v[92:95], a[104:107], v[36:39], v[92:95]
    v_mfma_f32_16x16x32_bf16 v[96:99], a[108:111], v[36:39], v[96:99]
    s_add_u32 s7, s88, 200704
    buffer_load_dwordx4 v[36:39], v3, s[40:43], s7 offen sc1
    s_waitcnt vmcnt(5)
D_chk23:
    v_max_u32 v7, v40, v43
    v_cmp_eq_u32 vcc, -1, v7
    s_cbranch_vccnz D_retry23
D_go23:
    v_mfma_f32_16x16x32_bf16 v[84:87], a[112:115], v[40:43], v[84:87]
    v_mfma_f32_16x16x32_bf16 v[88:91], a[116:119], v[40:43], v[88:91]
    v_mfma_f32_16x16x32_bf16 v[92:95], a[120:123], v[40:43], v[92:95]
    v_mfma_f32_16x16x32_bf16 v[96:99], a[124:127], v[40:43], v[96:99]
    s_add_u32 s7, s88, 201728
    buffer_load_dwordx4 v[40:43], v3, s[40:43], s7 offen sc1
    s_waitcnt lgkmcnt(0)
    s_waitcnt vmcnt(5)
D_chk24:
    v_max_u32 v7, v20, v23
    v_cmp_eq_u32 vcc, -1, v7
    s_cbranch_vccnz D_retry24
D_go24:
    v_mfma_f32_16x16x32_bf16 v[100:103], a[0:3], v[20:23], 0
    v_mfma_f32_16x16x32_bf16 v[104:107], a[4:7], v[20:23], 0
    v_mfma_f32_16x16x32_bf16 v[108:111], a[8:11], v[20:23], 0
    v_mfma_f32_16x16x32_bf16 v[112:115], a[12:15], v[20:23], 0
    s_add_u32 s7, s88, 202752
    buffer_load_dwordx4 v[20:23], v3, s[40:43], s7 offen sc1
    s_waitcnt vmcnt(5)
D_chk25:
    v_max_u32 v7, v24, v27
    v_cmp_eq_u32 vcc, -1, v7
    s_cbranch_vccnz D_retry25
D_go25:
    v_mfma_f32_16x16x32_bf16 v[100:103], a[16:19], v[24:27], v[100:103]
    v_mfma_f32_16x16x32_bf16 v[104:107], a[20:23], v[24:27], v[104:107]
    v_mfma_f32_16x16x32_bf16 v[108:111], a[24:27], v[24:27], v[108:111]
    v_mfma_f32_16x16x32_bf16 v[112:115], a[28:31], v[24:27], v[112:115]
    s_add_u32 s7, s88, 203776
    buffer_load_dwordx4 v[24:27], v3, s[40:43], s7 offen sc1
    ds_write_b128 v9, v[84:87] offset:8192
    ds_write_b128 v9, v[88:91] offset:9216
    ds_write_b128 v9, v[92:95] offset:10240
    ds_write_b128 v9, v[96:99] offset:11264
    s_waitcnt vmcnt(5)
D_chk26:
    v_max_u32 v7, v28, v31
    v_cmp_eq_u32 vcc, -1, v7
    s_cbranch_vccnz D_retry26
D_go26:
    v_mfma_f32_16x16x32_bf16 v[100:103], a[32:35], v[28:31], v[100:103]
    v_mfma_f32_16x16x32_bf16 v[104:107], a[36:39], v[28:31], v[104:107]
    v_mfma_f32_16x16x32_bf16 v[108:111], a[40:43], v[28:31], v[108:111]
    v_mfma_f32_16x16x32_bf16 v[112:115], a[44:47], v[28:31], v[112:115]
    s_add_u32 m0, s89, 0
    s_add_u32 s17, s87, 0
    buffer_load_dwordx4 v13, s[52:55], s17 offen lds
    s_add_u32 m0, s89, 1024
    s_add_u32 s17, s87, 32768
    buffer_load_dwordx4 v13, s[52:55], s17 offen lds
    s_add_u32 m0, s89, 2048
    s_add_u32 s17, s87, 65536
    buffer_load_dwordx4 v13, s[52:55], s17 offen lds
    s_add_u32 m0, s89, 3072
    s_add_u32 s17, s87, 98304
    buffer_load_dwordx4 v13, s[52:55], s17 offen lds
    s_waitcnt vmcnt(8)
D_chk27:
    v_max_u32 v7, v32, v35
    v_cmp_eq_u32 vcc, -1, v7
    s_cbranch_vccnz D_retry27
D_go27:
    v_mfma_f32_16x16x32_bf16 v[100:103], a[48:51], v[32:35], v[100:103]
    v_mfma_f32_16x16x32_bf16 v[104:107], a[52:55], v[32:35], v[104:107]
    v_mfma_f32_16x16x32_bf16 v[108:111], a[56:59], v[32:35], v[108:111]
    v_mfma_f32_16x16x32_bf16 v[112:115], a[60:63], v[32:35], v[112:115]
    s_waitcnt vmcnt(7)
D_chk28:
    v_max_u32 v7, v36, v39
    v_cmp_eq_u32 vcc, -1, v7
    s_cbranch_vccnz D_retry28
D_go28:
    v_mfma_f32_16x16x32_bf16 v[100:103], a[64:67], v[36:39], v[100:103]
    v_mfma_f32_16x16x32_bf16 v[104:107], a[68:71], v[36:39], v[104:107]
    v_mfma_f32_16x16x32_bf16 v[108:111], a[72:75], v[36:39], v[108:111]
    v_mfma_f32_16x16x32_bf16 v[112:115], a[76:79], v[36:39], v[112:115]
    s_waitcnt vmcnt(6)
D_chk29:
    v_max_u32 v7, v40, v43
    v_cmp_eq_u32 vcc, -1, v7
    s_cbranch_vccnz D_retry29
D_go29:
    v_mfma_f32_16x16x32_bf16 v[100:103], a[80:83], v[40:43], v[100:103]
    v_mfma_f32_16x16x32_bf16 v[104:107], a[84:87], v[40:43], v[104:107]
    v_mfma_f32_16x16x32_bf16 v[108:111], a[88:91], v[40:43], v[108:111]
    v_mfma_f32_16x16x32_bf16 v[112:115], a[92:95], v[40:43], v[112:115]
    s_waitcnt vmcnt(5)
D_chk30:
    v_max_u32 v7, v20, v23
    v_cmp_eq_u32 vcc, -1, v7
    s_cbranch_vccnz D_retry30
D_go30:
    v_mfma_f32_16x16x32_bf16 v[100:103], a[96:99], v[20:23], v[100:103]
    v_mfma_f32_16x16x32_bf16 v[104:107], a[100:103], v[20:23], v[104:107]
    v_mfma_f32_16x16x32_bf16 v[108:111], a[104:107], v[20:23], v[108:111]
    v_mfma_f32_16x16x32_bf16 v[112:115], a[108:111], v[20:23], v[112:115]
    s_waitcnt vmcnt(4)
D_chk31:
    v_max_u32 v7, v24, v27
    v_cmp_eq_u32 vcc, -1, v7
    s_cbranch_vccnz D_retry31
D_go31:
    v_mfma_f32_16x16x32_bf16 v[100:103], a[112:115], v[24:27], v[100:103]
    v_mfma_f32_16x16x32_bf16 v[104:107], a[116:119], v[24:27], v[104:107]
    v_mfma_f32_16x16x32_bf16 v[108:111], a[120:123], v[24:27], v[108:111]
    v_mfma_f32_16x16x32_bf16 v[112:115], a[124:127], v[24:27], v[112:115]
    s_nop 4
    ds_write_b128 v9, v[100:103] offset:12288
    ds_write_b128 v9, v[104:107] offset:13312
    ds_write_b128 v9, v[108:111] offset:14336
    ds_write_b128 v9, v[112:115] offset:15360
    v_add_u32 v19, 65536, v11
    s_waitcnt lgkmcnt(0)
    s_barrier
    ds_read_b128 v[20:23], v11 offset:0
    ds_read_b128 v[24:27], v11 offset:1024
    ds_read_b128 v[28:31], v11 offset:16384
    ds_read_b128 v[32:35], v11 offset:17408
    ds_read_b128 v[36:39], v11 offset:32768
    ds_read_b128 v[40:43], v11 offset:33792
    ds_read_b128 v[44:47], v11 offset:49152
    ds_read_b128 v[48:51], v11 offset:50176
    ds_read_b128 v[52:55], v19 offset:0
    ds_read_b128 v[56:59], v19 offset:1024
    ds_read_b128 v[60:63], v19 offset:16384
    ds_read_b128 v[64:67], v19 offset:17408
    ds_read_b128 v[68:71], v19 offset:32768
    ds_read_b128 v[72:75], v19 offset:33792
    ds_read_b128 v[76:79], v19 offset:49152
    ds_read_b128 v[80:83], v19 offset:50176
    s_waitcnt lgkmcnt(12)
    v_pk_add_f32 v[20:21], v[20:21], v[28:29]
    v_pk_add_f32 v[22:23], v[22:23], v[30:31]
    v_pk_add_f32 v[24:25], v[24:25], v[32:33]
    v_pk_add_f32 v[26:27], v[26:27], v[34:35]
    s_waitcnt lgkmcnt(8)
    v_pk_add_f32 v[36:37], v[36:37], v[44:45]
    v_pk_add_f32 v[38:39], v[38:39], v[46:47]
    v_pk_add_f32 v[40:41], v[40:41], v[48:49]
    v_pk_add_f32 v[42:43], v[42:43], v[50:51]
    v_pk_add_f32 v[20:21], v[20:21], v[36:37]
    v_pk_add_f32 v[22:23], v[22:23], v[38:39]
    v_pk_add_f32 v[24:25], v[24:25], v[40:41]
    v_pk_add_f32 v[26:27], v[26:27], v[42:43]
    s_waitcnt lgkmcnt(4)
    v_pk_add_f32 v[52:53], v[52:53], v[60:61]
    v_pk_add_f32 v[54:55], v[54:55], v[62:63]
    v_pk_add_f32 v[56:57], v[56:57], v[64:65]
    v_pk_add_f32 v[58:59], v[58:59], v[66:67]
    s_waitcnt lgkmcnt(0)
    v_pk_add_f32 v[68:69], v[68:69], v[76:77]
    v_pk_add_f32 v[70:71], v[70:71], v[78:79]
    v_pk_add_f32 v[72:73], v[72:73], v[80:81]
    v_pk_add_f32 v[74:75], v[74:75], v[82:83]
    v_pk_add_f32 v[52:53], v[52:53], v[68:69]
    v_pk_add_f32 v[54:55], v[54:55], v[70:71]
    v_pk_add_f32 v[56:57], v[56:57], v[72:73]
    v_pk_add_f32 v[58:59], v[58:59], v[74:75]
    v_pk_add_f32 v[20:21], v[20:21], v[52:53]
    v_pk_add_f32 v[22:23], v[22:23], v[54:55]
    v_pk_add_f32 v[24:25], v[24:25], v[56:57]
    v_pk_add_f32 v[26:27], v[26:27], v[58:59]
    v_cvt_pk_bf16_f32 v21, v20, v21
    v_cvt_pk_bf16_f32 v23, v22, v23
    v_cvt_pk_bf16_f32 v25, v24, v25
    v_cvt_pk_bf16_f32 v27, v26, v27
    v_lshlrev_b32 v20, 16, v21
    v_and_b32 v21, 0xffff0000, v21
    v_lshlrev_b32 v22, 16, v23
    v_and_b32 v23, 0xffff0000, v23
    v_lshlrev_b32 v24, 16, v25
    v_and_b32 v25, 0xffff0000, v25
    v_lshlrev_b32 v26, 16, v27
    v_and_b32 v27, 0xffff0000, v27
    v_lshlrev_b32 v84, 16, v116
    v_and_b32 v85, 0xffff0000, v116
    v_lshlrev_b32 v86, 16, v117
    v_and_b32 v87, 0xffff0000, v117
    v_lshlrev_b32 v88, 16, v118
    v_and_b32 v89, 0xffff0000, v118
    v_lshlrev_b32 v90, 16, v119
    v_and_b32 v91, 0xffff0000, v119
    v_pk_add_f32 v[20:21], v[20:21], v[84:85]
    v_pk_add_f32 v[22:23], v[22:23], v[86:87]
    v_pk_add_f32 v[24:25], v[24:25], v[88:89]
    v_pk_add_f32 v[26:27], v[26:27], v[90:91]
    v_cvt_pk_bf16_f32 v21, v20, v21
    v_cvt_pk_bf16_f32 v23, v22, v23
    v_cvt_pk_bf16_f32 v25, v24, v25
    v_cvt_pk_bf16_f32 v27, v26, v27
    v_lshlrev_b32 v20, 16, v21
    v_and_b32 v21, 0xffff0000, v21
    v_lshlrev_b32 v22, 16, v23
    v_and_b32 v23, 0xffff0000, v23
    v_lshlrev_b32 v24, 16, v25
    v_and_b32 v25, 0xffff0000, v25
    v_lshlrev_b32 v26, 16, v27
    v_and_b32 v27, 0xffff0000, v27
    s_mov_b32 s16, 0xbdd2d3e8
    s_mov_b32 s17, 0xbdd2d3e8
    v_mov_b32 v120, 0xc0135761
    v_mov_b32 v121, 0xc0135761
    v_pk_mul_f32 v[84:85], v[20:21], v[20:21]
    v_pk_mul_f32 v[86:87], v[22:23], v[22:23]
    v_pk_mul_f32 v[88:89], v[24:25], v[24:25]
    v_pk_mul_f32 v[90:91], v[26:27], v[26:27]
    v_pk_fma_f32 v[84:85], v[84:85], s[16:17], v[120:121]
    v_pk_fma_f32 v[86:87], v[86:87], s[16:17], v[120:121]
    v_pk_fma_f32 v[88:89], v[88:89], s[16:17], v[120:121]
    v_pk_fma_f32 v[90:91], v[90:91], s[16:17], v[120:121]
    v_pk_mul_f32 v[84:85], v[84:85], v[20:21]
    v_pk_mul_f32 v[86:87], v[86:87], v[22:23]
    v_pk_mul_f32 v[88:89], v[88:89], v[24:25]
    v_pk_mul_f32 v[90:91], v[90:91], v[26:27]
    v_exp_f32 v84, v84
    v_exp_f32 v85, v85
    v_exp_f32 v86, v86
    v_exp_f32 v87, v87
    v_exp_f32 v88, v88
    v_exp_f32 v89, v89
    v_exp_f32 v90, v90
    v_exp_f32 v91, v91
    v_pk_add_f32 v[84:85], v[84:85], 1.0 op_sel_hi:[1,0]
    v_pk_add_f32 v[86:87], v[86:87], 1.0 op_sel_hi:[1,0]
    v_pk_add_f32 v[88:89], v[88:89], 1.0 op_sel_hi:[1,0]
    v_pk_add_f32 v[90:91], v[90:91], 1.0 op_sel_hi:[1,0]
    v_rcp_f32 v84, v84
    v_rcp_f32 v85, v85
    v_rcp_f32 v86, v86
    v_rcp_f32 v87, v87
    v_rcp_f32 v88, v88
    v_rcp_f32 v89, v89
    v_rcp_f32 v90, v90
    v_rcp_f32 v91, v91
    v_pk_mul_f32 v[20:21], v[20:21], v[84:85]
    v_pk_mul_f32 v[22:23], v[22:23], v[86:87]
    v_pk_mul_f32 v[24:25], v[24:25], v[88:89]
    v_pk_mul_f32 v[26:27], v[26:27], v[90:91]
    v_cvt_pk_bf16_f32 v92, v20, v21
    v_cvt_pk_bf16_f32 v93, v22, v23
    v_cvt_pk_bf16_f32 v94, v24, v25
    v_cvt_pk_bf16_f32 v95, v26, v27
    buffer_store_dwordx4 v[92:95], v3, s[44:47], s84 offen sc1
    s_barrier
    s_branch Z_E
Z_idle1:
    v_and_b32 v7, 31, v0
    v_lshlrev_b32 v7, 4, v7
    v_lshrrev_b32 v8, 5, v0
    v_lshl_add_u32 v7, v8, 12, v7
    s_lshl_b32 s6, s101, 9
    s_cmp_eq_u32 s101, 7
    s_cselect_b32 s90, 4, 28
    s_cselect_b32 s91, 0, 28
    s_cselect_b32 s16, 32, 4
    s_lshl_b32 s16, s16, 16
    s_sub_u32 s7, s100, s91
    s_lshl_b32 s7, s7, 16
    s_add_u32 s6, s6, s7
Z_idle_loop:
    buffer_load_dwordx4 v[84:87], v7, s[52:55], s6 offen
    s_add_u32 s6, s6, s16
    s_sub_u32 s90, s90, 1
    s_cmp_lg_u32 s90, 0
    s_cbranch_scc1 Z_idle_loop
    s_cmp_eq_u32 s77, 0
    s_cbranch_scc1 Z_fin
    v_lshlrev_b32 v7, 8, v10
    s_mov_b32 s6, 0
Z_idle_probe:
    buffer_load_dword v8, v7, s[40:43], 0 offen sc1
    s_add_u32 s6, s6, 1
    s_waitcnt vmcnt(0)
    v_cmp_eq_u32 vcc, -1, v8
    s_cmp_ge_u32 s6, 1048576
    s_cbranch_scc1 Z_idle_probe_done
    s_cbranch_vccnz Z_idle_probe
Z_idle_probe_done:
    s_barrier
    s_add_u32 m0, s89, 0
    s_add_u32 s17, s87, 0
    buffer_load_dwordx4 v13, s[52:55], s17 offen lds
    s_add_u32 m0, s89, 1024
    s_add_u32 s17, s87, 32768
    buffer_load_dwordx4 v13, s[52:55], s17 offen lds
    s_add_u32 m0, s89, 2048
    s_add_u32 s17, s87, 65536
    buffer_load_dwordx4 v13, s[52:55], s17 offen lds
    s_add_u32 m0, s89, 3072
    s_add_u32 s17, s87, 98304
    buffer_load_dwordx4 v13, s[52:55], s17 offen lds
    buffer_load_dword v8, v7, s[40:43], 0 offen sc1
Z_E:
    s_add_u32 m0, s85, 0
    s_add_u32 s17, s87, 131072
    buffer_load_dwordx4 v13, s[52:55], s17 offen lds
    s_add_u32 m0, s85, 1024
    s_add_u32 s17, s87, 163840
    buffer_load_dwordx4 v13, s[52:55], s17 offen lds
    s_add_u32 m0, s85, 2048
    s_add_u32 s17, s87, 196608
    buffer_load_dwordx4 v13, s[52:55], s17 offen lds
    s_add_u32 m0, s85, 3072
    s_add_u32 s17, s87, 229376
    buffer_load_dwordx4 v13, s[52:55], s17 offen lds
    s_add_u32 m0, s85, 4096
    s_add_u32 s17, s87, 262144
    buffer_load_dwordx4 v13, s[52:55], s17 offen lds
    s_add_u32 m0, s85, 5120
    s_add_u32 s17, s87, 294912
    buffer_load_dwordx4 v13, s[52:55], s17 offen lds
    s_add_u32 m0, s85, 6144
    s_add_u32 s17, s87, 327680
    buffer_load_dwordx4 v13, s[52:55], s17 offen lds
    s_add_u32 m0, s85, 7168
    s_add_u32 s17, s87, 360448
    buffer_load_dwordx4 v13, s[52:55], s17 offen lds
    s_add_u32 m0, s85, 8192
    s_add_u32 s17, s87, 393216
    buffer_load_dwordx4 v13, s[52:55], s17 offen lds
    s_add_u32 m0, s85, 9216
    s_add_u32 s17, s87, 425984
    buffer_load_dwordx4 v13, s[52:55], s17 offen lds
    s_add_u32 m0, s85, 10240
    s_add_u32 s17, s87, 458752
    buffer_load_dwordx4 v13, s[52:55], s17 offen lds
    s_add_u32 m0, s85, 11264
    s_add_u32 s17, s87, 491520
    buffer_load_dwordx4 v13, s[52:55], s17 offen lds
    s_add_u32 m0, s85, 12288
    s_add_u32 s17, s87, 524288
    buffer_load_dwordx4 v13, s[52:55], s17 offen lds
    s_add_u32 m0, s85, 13312
    s_add_u32 s17, s87, 557056
    buffer_load_dwordx4 v13, s[52:55], s17 offen lds
    s_add_u32 m0, s85, 14336
    s_add_u32 s17, s87, 589824
    buffer_load_dwordx4 v13, s[52:55], s17 offen lds
    s_add_u32 m0, s85, 15360
    s_add_u32 s17, s87, 622592
    buffer_load_dwordx4 v13, s[52:55], s17 offen lds
    s_sub_u32 s3, s89, s85
    v_add_u32 v20, s3, v14
    v_add_u32 v21, s3, v15
    v_add_u32 v22, s3, v16
    v_add_u32 v23, s3, v17
    s_waitcnt vmcnt(17)
    ds_read_b64_tr_b16 a[0:1], v20 offset:0
    ds_read_b64_tr_b16 a[2:3], v20 offset:2048
    ds_read_b64_tr_b16 a[4:5], v21 offset:0
    ds_read_b64_tr_b16 a[6:7], v21 offset:2048
    ds_read_b64_tr_b16 a[8:9], v22 offset:0
    ds_read_b64_tr_b16 a[10:11], v22 offset:2048
    ds_read_b64_tr_b16 a[12:13], v23 offset:0
    ds_read_b64_tr_b16 a[14:15], v23 offset:2048
    s_waitcnt vmcnt(12)
    ds_read_b64_tr_b16 a[16:17], v14 offset:0
    ds_read_b64_tr_b16 a[18:19], v14 offset:2048
    ds_read_b64_tr_b16 a[20:21], v15 offset:0
    ds_read_b64_tr_b16 a[22:23], v15 offset:2048
    ds_read_b64_tr_b16 a[24:25], v16 offset:0
    ds_read_b64_tr_b16 a[26:27], v16 offset:2048
    ds_read_b64_tr_b16 a[28:29], v17 offset:0
    ds_read_b64_tr_b16 a[30:31], v17 offset:2048
    s_waitcnt lgkmcnt(0)
    s_add_u32 m0, s85, 0
    s_add_u32 s17, s87, 655360
    buffer_load_dwordx4 v13, s[52:55], s17 offen lds
    s_add_u32 m0, s85, 1024
    s_add_u32 s17, s87, 688128
    buffer_load_dwordx4 v13, s[52:55], s17 offen lds
    s_add_u32 m0, s85, 2048
    s_add_u32 s17, s87, 720896
    buffer_load_dwordx4 v13, s[52:55], s17 offen lds
    s_add_u32 m0, s85, 3072
    s_add_u32 s17, s87, 753664
    buffer_load_dwordx4 v13, s[52:55], s17 offen lds
    s_waitcnt vmcnt(12)
    ds_read_b64_tr_b16 a[32:33], v14 offset:4096
    ds_read_b64_tr_b16 a[34:35], v14 offset:6144
    ds_read_b64_tr_b16 a[36:37], v15 offset:4096
    ds_read_b64_tr_b16 a[38:39], v15 offset:6144
    ds_read_b64_tr_b16 a[40:41], v16 offset:4096
    ds_read_b64_tr_b16 a[42:43], v16 offset:6144
    ds_read_b64_tr_b16 a[44:45], v17 offset:4096
    ds_read_b64_tr_b16 a[46:47], v17 offset:6144
    s_waitcnt lgkmcnt(0)
    s_add_u32 m0, s85, 4096
    s_add_u32 s17, s87, 786432
    buffer_load_dwordx4 v13, s[52:55], s17 offen lds
    s_add_u32 m0, s85, 5120
    s_add_u32 s17, s87, 819200
    buffer_load_dwordx4 v13, s[52:55], s17 offen lds
    s_add_u32 m0, s85, 6144
    s_add_u32 s17, s87, 851968
    buffer_load_dwordx4 v13, s[52:55], s17 offen lds
    s_add_u32 m0, s85, 7168
    s_add_u32 s17, s87, 884736
    buffer_load_dwordx4 v13, s[52:55], s17 offen lds
    s_mul_i32 s88, s75, 229376
    s_mul_i32 s3, s19, 7168
    s_add_u32 s88, s88, s3
    v_min_u32 v7, 6, v6
    v_lshlrev_b32 v8, 10, v7
    v_mul_u32_u24 v7, 57344, v5
    v_add_u32 v8, v8, v7
    s_lshl_b32 s16, s18, 10
    s_lshr_b32 s17, s72, 2
    s_lshl_b32 s17, s17, 13
    s_add_u32 s16, s16, s17
    s_add_u32 s16, s16, 16384
    v_add_u32 v11, s16, v3
    s_lshl_b32 s16, s74, 6
    s_lshl_b32 s17, s18, 4
    s_add_u32 s16, s16, s17
    v_add_u32 v7, s16, v6
    v_mul_u32_u24 v4, 896, v7
    v_lshl_add_u32 v4, v5, 5, v4
    v_lshlrev_b32 v7, 1, v7
    s_lshl_b32 s84, s75, 7
    s_lshr_b32 s3, s72, 2
    s_lshl_b32 s3, s3, 4
    s_add_u32 s84, s84, s3
    v_mov_b32 v120, 0
    buffer_load_short_d16_hi v120, v7, s[60:63], 0 offen
    s_mov_b32 s6, 0
E_probe:
    buffer_load_dword v7, v8, s[44:47], s88 offen sc1
    s_add_u32 s6, s6, 1
    s_waitcnt vmcnt(0)
    v_cmp_eq_u32 vcc, -1, v7
    s_cmp_ge_u32 s6, 1048576
    s_cbranch_scc1 E_probe_done
    s_and_b64 exec, exec, vcc
    s_cbranch_execnz E_probe
E_probe_done:
    s_mov_b64 exec, -1
    s_add_u32 s7, s88, 0
    buffer_load_dwordx4 v[20:23], v3, s[44:47], s7 offen sc1
    s_add_u32 s7, s88, 1024
    buffer_load_dwordx4 v[24:27], v3, s[44:47], s7 offen sc1
    s_add_u32 s7, s88, 2048
    buffer_load_dwordx4 v[28:31], v3, s[44:47], s7 offen sc1
    s_add_u32 s7, s88, 3072
    buffer_load_dwordx4 v[32:35], v3, s[44:47], s7 offen sc1
    s_add_u32 s7, s88, 4096
    buffer_load_dwordx4 v[36:39], v3, s[44:47], s7 offen sc1
    s_add_u32 s7, s88, 5120
    buffer_load_dwordx4 v[40:43], v3, s[44:47], s7 offen sc1
    s_waitcnt vmcnt(20)
    ds_read_b64_tr_b16 a[48:49], v14 offset:8192
    ds_read_b64_tr_b16 a[50:51], v14 offset:10240
    ds_read_b64_tr_b16 a[52:53], v15 offset:8192
    ds_read_b64_tr_b16 a[54:55], v15 offset:10240
    ds_read_b64_tr_b16 a[56:57], v16 offset:8192
    ds_read_b64_tr_b16 a[58:59], v16 offset:10240
    ds_read_b64_tr_b16 a[60:61], v17 offset:8192
    ds_read_b64_tr_b16 a[62:63], v17 offset:10240
    s_waitcnt vmcnt(16)
    ds_read_b64_tr_b16 a[64:65], v14 offset:12288
    ds_read_b64_tr_b16 a[66:67], v14 offset:14336
    ds_read_b64_tr_b16 a[68:69], v15 offset:12288
    ds_read_b64_tr_b16 a[70:71], v15 offset:14336
    ds_read_b64_tr_b16 a[72:73], v16 offset:12288
    ds_read_b64_tr_b16 a[74:75], v16 offset:14336
    ds_read_b64_tr_b16 a[76:77], v17 offset:12288
    ds_read_b64_tr_b16 a[78:79], v17 offset:14336
    s_waitcnt vmcnt(12)
    ds_read_b64_tr_b16 a[80:81], v14 offset:0
    ds_read_b64_tr_b16 a[82:83], v14 offset:2048
    ds_read_b64_tr_b16 a[84:85], v15 offset:0
    ds_read_b64_tr_b16 a[86:87], v15 offset:2048
    ds_read_b64_tr_b16 a[88:89], v16 offset:0
    ds_read_b64_tr_b16 a[90:91], v16 offset:2048
    ds_read_b64_tr_b16 a[92:93], v17 offset:0
    ds_read_b64_tr_b16 a[94:95], v17 offset:2048
    s_waitcnt vmcnt(8)
    ds_read_b64_tr_b16 a[96:97], v14 offset:4096
    ds_read_b64_tr_b16 a[98:99], v14 offset:6144
    ds_read_b64_tr_b16 a[100:101], v15 offset:4096
    ds_read_b64_tr_b16 a[102:103], v15 offset:6144
    ds_read_b64_tr_b16 a[104:105], v16 offset:4096
    ds_read_b64_tr_b16 a[106:107], v16 offset:6144
    ds_read_b64_tr_b16 a[108:109], v17 offset:4096
    ds_read_b64_tr_b16 a[110:111], v17 offset:6144
    s_waitcnt lgkmcnt(0)
    s_waitcnt vmcnt(5)
E_chk0:
    v_max_u32 v7, v20, v23
    v_cmp_eq_u32 vcc, -1, v7
    s_cbranch_vccnz E_retry0
E_go0:
    v_mfma_f32_16x16x32_bf16 v[84:87], v[20:23], a[0:3], 0
    v_mfma_f32_16x16x32_bf16 v[88:91], v[20:23], a[4:7], 0
    v_mfma_f32_16x16x32_bf16 v[92:95], v[20:23], a[8:11], 0
    v_mfma_f32_16x16x32_bf16 v[96:99], v[20:23], a[12:15], 0
    s_add_u32 s7, s88, 6144
    buffer_load_dwordx4 v[20:23], v3, s[44:47], s7 offen sc1
    s_barrier
    s_waitcnt vmcnt(5)
E_chk1:
    v_max_u32 v7, v24, v27
    v_cmp_eq_u32 vcc, -1, v7
    s_cbranch_vccnz E_retry1
E_go1:
    v_mfma_f32_16x16x32_bf16 v[84:87], v[24:27], a[16:19], v[84:87]
    v_mfma_f32_16x16x32_bf16 v[88:91], v[24:27], a[20:23], v[88:91]
    v_mfma_f32_16x16x32_bf16 v[92:95], v[24:27], a[24:27], v[92:95]
    v_mfma_f32_16x16x32_bf16 v[96:99], v[24:27], a[28:31], v[96:99]
    s_add_u32 s7, s88, 57344
    buffer_load_dwordx4 v[24:27], v3, s[44:47], s7 offen sc1
    s_waitcnt vmcnt(5)
E_chk2:
    v_max_u32 v7, v28, v31
    v_cmp_eq_u32 vcc, -1, v7
    s_cbranch_vccnz E_retry2
E_go2:
    v_mfma_f32_16x16x32_bf16 v[84:87], v[28:31], a[32:35], v[84:87]
    v_mfma_f32_16x16x32_bf16 v[88:91], v[28:31], a[36:39], v[88:91]
    v_mfma_f32_16x16x32_bf16 v[92:95], v[28:31], a[40:43], v[92:95]
    v_mfma_f32_16x16x32_bf16 v[96:99], v[28:31], a[44:47], v[96:99]
    s_add_u32 s7, s88, 58368
    buffer_load_dwordx4 v[28:31], v3, s[44:47], s7 offen sc1
    s_waitcnt vmcnt(5)
E_chk3:
    v_max_u32 v7, v32, v35
    v_cmp_eq_u32 vcc, -1, v7
    s_cbranch_vccnz E_retry3
E_go3:
    v_mfma_f32_16x16x32_bf16 v[84:87], v[32:35], a[48:51], v[84:87]
    v_mfma_f32_16x16x32_bf16 v[88:91], v[32:35], a[52:55], v[88:91]
    v_mfma_f32_16x16x32_bf16 v[92:95], v[32:35], a[56:59], v[92:95]
    v_mfma_f32_16x16x32_bf16 v[96:99], v[32:35], a[60:63], v[96:99]
    s_add_u32 s7, s88, 59392
    buffer_load_dwordx4 v[32:35], v3, s[44:47], s7 offen sc1
    s_waitcnt vmcnt(5)
E_chk4:
    v_max_u32 v7, v36, v39
    v_cmp_eq_u32 vcc, -1, v7
    s_cbranch_vccnz E_retry4
E_go4:
    v_mfma_f32_16x16x32_bf16 v[84:87], v[36:39], a[64:67], v[84:87]
    v_mfma_f32_16x16x32_bf16 v[88:91], v[36:39], a[68:71], v[88:91]
    v_mfma_f32_16x16x32_bf16 v[92:95], v[36:39], a[72:75], v[92:95]
    v_mfma_f32_16x16x32_bf16 v[96:99], v[36:39], a[76:79], v[96:99]
    s_add_u32 s7, s88, 60416
    buffer_load_dwordx4 v[36:39], v3, s[44:47], s7 offen sc1
    s_waitcnt vmcnt(5)
E_chk5:
    v_max_u32 v7, v40, v43
    v_cmp_eq_u32 vcc, -1, v7
    s_cbranch_vccnz E_retry5
E_go5:
    v_mfma_f32_16x16x32_bf16 v[84:87], v[40:43], a[80:83], v[84:87]
    v_mfma_f32_16x16x32_bf16 v[88:91], v[40:43], a[84:87], v[88:91]
    v_mfma_f32_16x16x32_bf16 v[92:95], v[40:43], a[88:91], v[92:95]
    v_mfma_f32_16x16x32_bf16 v[96:99], v[40:43], a[92:95], v[96:99]
    s_add_u32 s7, s88, 61440
    buffer_load_dwordx4 v[40:43], v3, s[44:47], s7 offen sc1
    s_waitcnt vmcnt(5)
E_chk6:
    v_max_u32 v7, v20, v23
    v_cmp_eq_u32 vcc, -1, v7
    s_cbranch_vccnz E_retry6
E_go6:
    v_mfma_f32_16x16x32_bf16 v[84:87], v[20:23], a[96:99], v[84:87]
    v_mfma_f32_16x16x32_bf16 v[88:91], v[20:23], a[100:103], v[88:91]
    v_mfma_f32_16x16x32_bf16 v[92:95], v[20:23], a[104:107], v[92:95]
    v_mfma_f32_16x16x32_bf16 v[96:99], v[20:23], a[108:111], v[96:99]
    s_add_u32 s7, s88, 62464
    buffer_load_dwordx4 v[20:23], v3, s[44:47], s7 offen sc1
    s_waitcnt vmcnt(5)
E_chk7:
    v_max_u32 v7, v24, v27
    v_cmp_eq_u32 vcc, -1, v7
    s_cbranch_vccnz E_retry7
E_go7:
    v_mfma_f32_16x16x32_bf16 v[100:103], v[24:27], a[0:3], 0
    v_mfma_f32_16x16x32_bf16 v[104:107], v[24:27], a[4:7], 0
    v_mfma_f32_16x16x32_bf16 v[108:111], v[24:27], a[8:11], 0
    v_mfma_f32_16x16x32_bf16 v[112:115], v[24:27], a[12:15], 0
    s_add_u32 s7, s88, 63488
    buffer_load_dwordx4 v[24:27], v3, s[44:47], s7 offen sc1
    s_waitcnt vmcnt(5)
E_chk8:
    v_max_u32 v7, v28, v31
    v_cmp_eq_u32 vcc, -1, v7
    s_cbranch_vccnz E_retry8
E_go8:
    v_mfma_f32_16x16x32_bf16 v[100:103], v[28:31], a[16:19], v[100:103]
    v_mfma_f32_16x16x32_bf16 v[104:107], v[28:31], a[20:23], v[104:107]
    v_mfma_f32_16x16x32_bf16 v[108:111], v[28:31], a[24:27], v[108:111]
    v_mfma_f32_16x16x32_bf16 v[112:115], v[28:31], a[28:31], v[112:115]
    s_add_u32 s7, s88, 114688
    buffer_load_dwordx4 v[28:31], v3, s[44:47], s7 offen sc1
    ds_write_b128 v9, v[84:87] offset:0
    ds_write_b128 v9, v[88:91] offset:1024
    ds_write_b128 v9, v[92:95] offset:2048
    ds_write_b128 v9, v[96:99] offset:3072
    s_waitcnt vmcnt(5)
E_chk9:
    v_max_u32 v7, v32, v35
    v_cmp_eq_u32 vcc, -1, v7
    s_cbranch_vccnz E_retry9
E_go9:
    v_mfma_f32_16x16x32_bf16 v[100:103], v[32:35], a[32:35], v[100:103]
    v_mfma_f32_16x16x32_bf16 v[104:107], v[32:35], a[36:39], v[104:107]
    v_mfma_f32_16x16x32_bf16 v[108:111], v[32:35], a[40:43], v[108:111]
    v_mfma_f32_16x16x32_bf16 v[112:115], v[32:35], a[44:47], v[112:115]
    s_add_u32 s7, s88, 115712
    buffer_load_dwordx4 v[32:35], v3, s[44:47], s7 offen sc1
    s_waitcnt vmcnt(5)
E_chk10:
    v_max_u32 v7, v36, v39
    v_cmp_eq_u32 vcc, -1, v7
    s_cbranch_vccnz E_retry10
E_go10:
    v_mfma_f32_16x16x32_bf16 v[100:103], v[36:39], a[48:51], v[100:103]
    v_mfma_f32_16x16x32_bf16 v[104:107], v[36:39], a[52:55], v[104:107]
    v_mfma_f32_16x16x32_bf16 v[108:111], v[36:39], a[56:59], v[108:111]
    v_mfma_f32_16x16x32_bf16 v[112:115], v[36:39], a[60:63], v[112:115]
    s_add_u32 s7, s88, 116736
    buffer_load_dwordx4 v[36:39], v3, s[44:47], s7 offen sc1
    s_waitcnt vmcnt(5)
E_chk11:
    v_max_u32 v7, v40, v43
    v_cmp_eq_u32 vcc, -1, v7
    s_cbranch_vccnz E_retry11
E_go11:
    v_mfma_f32_16x16x32_bf16 v[100:103], v[40:43], a[64:67], v[100:103]
    v_mfma_f32_16x16x32_bf16 v[104:107], v[40:43], a[68:71], v[104:107]
    v_mfma_f32_16x16x32_bf16 v[108:111], v[40:43], a[72:75], v[108:111]
    v_mfma_f32_16x16x32_bf16 v[112:115], v[40:43], a[76:79], v[112:115]
    s_add_u32 s7, s88, 117760
    buffer_load_dwordx4 v[40:43], v3, s[44:47], s7 offen sc1
    s_waitcnt vmcnt(5)
E_chk12:
    v_max_u32 v7, v20, v23
    v_cmp_eq_u32 vcc, -1, v7
    s_cbranch_vccnz E_retry12
E_go12:
    v_mfma_f32_16x16x32_bf16 v[100:103], v[20:23], a[80:83], v[100:103]
    v_mfma_f32_16x16x32_bf16 v[104:107], v[20:23], a[84:87], v[104:107]
    v_mfma_f32_16x16x32_bf16 v[108:111], v[20:23], a[88:91], v[108:111]
    v_mfma_f32_16x16x32_bf16 v[112:115], v[20:23], a[92:95], v[112:115]
    s_add_u32 s7, s88, 118784
    buffer_load_dwordx4 v[20:23], v3, s[44:47], s7 offen sc1
    s_waitcnt vmcnt(5)
E_chk13:
    v_max_u32 v7, v24, v27
    v_cmp_eq_u32 vcc, -1, v7
    s_cbranch_vccnz E_retry13
E_go13:
    v_mfma_f32_16x16x32_bf16 v[100:103], v[24:27], a[96:99], v[100:103]
    v_mfma_f32_16x16x32_bf16 v[104:107], v[24:27], a[100:103], v[104:107]
    v_mfma_f32_16x16x32_bf16 v[108:111], v[24:27], a[104:107], v[108:111]
    v_mfma_f32_16x16x32_bf16 v[112:115], v[24:27], a[108:111], v[112:115]
    s_add_u32 s7, s88, 119808
    buffer_load_dwordx4 v[24:27], v3, s[44:47], s7 offen sc1
    s_waitcnt lgkmcnt(0)
    s_waitcnt vmcnt(5)
E_chk14:
    v_max_u32 v7, v28, v31
    v_cmp_eq_u32 vcc, -1, v7
    s_cbranch_vccnz E_retry14
E_go14:
    v_mfma_f32_16x16x32_bf16 v[84:87], v[28:31], a[0:3], 0
    v_mfma_f32_16x16x32_bf16 v[88:91], v[28:31], a[4:7], 0
    v_mfma_f32_16x16x32_bf16 v[92:95], v[28:31], a[8:11], 0
    v_mfma_f32_16x16x32_bf16 v[96:99], v[28:31], a[12:15], 0
    s_add_u32 s7, s88, 120832
    buffer_load_dwordx4 v[28:31], v3, s[44:47], s7 offen sc1
    s_waitcnt vmcnt(5)
E_chk15:
    v_max_u32 v7, v32, v35
    v_cmp_eq_u32 vcc, -1, v7
    s_cbranch_vccnz E_retry15
E_go15:
    v_mfma_f32_16x16x32_bf16 v[84:87], v[32:35], a[16:19], v[84:87]
    v_mfma_f32_16x16x32_bf16 v[88:91], v[32:35], a[20:23], v[88:91]
    v_mfma_f32_16x16x32_bf16 v[92:95], v[32:35], a[24:27], v[92:95]
    v_mfma_f32_16x16x32_bf16 v[96:99], v[32:35], a[28:31], v[96:99]
    s_add_u32 s7, s88, 172032
    buffer_load_dwordx4 v[32:35], v3, s[44:47], s7 offen sc1
    ds_write_b128 v9, v[100:103] offset:4096
    ds_write_b128 v9, v[104:107] offset:5120
    ds_write_b128 v9, v[108:111] offset:6144
    ds_write_b128 v9, v[112:115] offset:7168
    s_waitcnt vmcnt(5)
E_chk16:
    v_max_u32 v7, v36, v39
    v_cmp_eq_u32 vcc, -1, v7
    s_cbranch_vccnz E_retry16
E_go16:
    v_mfma_f32_16x16x32_bf16 v[84:87], v[36:39], a[32:35], v[84:87]
    v_mfma_f32_16x16x32_bf16 v[88:91], v[36:39], a[36:39], v[88:91]
    v_mfma_f32_16x16x32_bf16 v[92:95], v[36:39], a[40:43], v[92:95]
    v_mfma_f32_16x16x32_bf16 v[96:99], v[36:39], a[44:47], v[96:99]
    s_add_u32 s7, s88, 173056
    buffer_load_dwordx4 v[36:39], v3, s[44:47], s7 offen sc1
    s_waitcnt vmcnt(5)
E_chk17:
    v_max_u32 v7, v40, v43
    v_cmp_eq_u32 vcc, -1, v7
    s_cbranch_vccnz E_retry17
E_go17:
    v_mfma_f32_16x16x32_bf16 v[84:87], v[40:43], a[48:51], v[84:87]
    v_mfma_f32_16x16x32_bf16 v[88:91], v[40:43], a[52:55], v[88:91]
    v_mfma_f32_16x16x32_bf16 v[92:95], v[40:43], a[56:59], v[92:95]
    v_mfma_f32_16x16x32_bf16 v[96:99], v[40:43], a[60:63], v[96:99]
    s_add_u32 s7, s88, 174080
    buffer_load_dwordx4 v[40:43], v3, s[44:47], s7 offen sc1
    s_waitcnt vmcnt(5)
E_chk18:
    v_max_u32 v7, v20, v23
    v_cmp_eq_u32 vcc, -1, v7
    s_cbranch_vccnz E_retry18
E_go18:
    v_mfma_f32_16x16x32_bf16 v[84:87], v[20:23], a[64:67], v[84:87]
    v_mfma_f32_16x16x32_bf16 v[88:91], v[20:23], a[68:71], v[88:91]
    v_mfma_f32_16x16x32_bf16 v[92:95], v[20:23], a[72:75], v[92:95]
    v_mfma_f32_16x16x32_bf16 v[96:99], v[20:23], a[76:79], v[96:99]
    s_add_u32 s7, s88, 175104
    buffer_load_dwordx4 v[20:23], v3, s[44:47], s7 offen sc1
    s_waitcnt vmcnt(5)
E_chk19:
    v_max_u32 v7, v24, v27
    v_cmp_eq_u32 vcc, -1, v7
    s_cbranch_vccnz E_retry19
E_go19:
    v_mfma_f32_16x16x32_bf16 v[84:87], v[24:27], a[80:83], v[84:87]
    v_mfma_f32_16x16x32_bf16 v[88:91], v[24:27], a[84:87], v[88:91]
    v_mfma_f32_16x16x32_bf16 v[92:95], v[24:27], a[88:91], v[92:95]
    v_mfma_f32_16x16x32_bf16 v[96:99], v[24:27], a[92:95], v[96:99]
    s_add_u32 s7, s88, 176128
    buffer_load_dwordx4 v[24:27], v3, s[44:47], s7 offen sc1
    s_waitcnt vmcnt(5)
E_chk20:
    v_max_u32 v7, v28, v31
    v_cmp_eq_u32 vcc, -1, v7
    s_cbranch_vccnz E_retry20
E_go20:
    v_mfma_f32_16x16x32_bf16 v[84:87], v[28:31], a[96:99], v[84:87]
    v_mfma_f32_16x16x32_bf16 v[88:91], v[28:31], a[100:103], v[88:91]
    v_mfma_f32_16x16x32_bf16 v[92:95], v[28:31], a[104:107], v[92:95]
    v_mfma_f32_16x16x32_bf16 v[96:99], v[28:31], a[108:111], v[96:99]
    s_add_u32 s7, s88, 177152
    buffer_load_dwordx4 v[28:31], v3, s[44:47], s7 offen sc1
    s_waitcnt lgkmcnt(0)
    s_waitcnt vmcnt(5)
E_chk21:
    v_max_u32 v7, v32, v35
    v_cmp_eq_u32 vcc, -1, v7
    s_cbranch_vccnz E_retry21
E_go21:
    v_mfma_f32_16x16x32_bf16 v[100:103], v[32:35], a[0:3], 0
    v_mfma_f32_16x16x32_bf16 v[104:107], v[32:35], a[4:7], 0
    v_mfma_f32_16x16x32_bf16 v[108:111], v[32:35], a[8:11], 0
    v_mfma_f32_16x16x32_bf16 v[112:115], v[32:35], a[12:15], 0
    s_add_u32 s7, s88, 178176
    buffer_load_dwordx4 v[32:35], v3, s[44:47], s7 offen sc1
    s_waitcnt vmcnt(5)
E_chk22:
    v_max_u32 v7, v36, v39
    v_cmp_eq_u32 vcc, -1, v7
    s_cbranch_vccnz E_retry22
E_go22:
    v_mfma_f32_16x16x32_bf16 v[100:103], v[36:39], a[16:19], v[100:103]
    v_mfma_f32_16x16x32_bf16 v[104:107], v[36:39], a[20:23], v[104:107]
    v_mfma_f32_16x16x32_bf16 v[108:111], v[36:39], a[24:27], v[108:111]
    v_mfma_f32_16x16x32_bf16 v[112:115], v[36:39], a[28:31], v[112:115]
    buffer_load_dwordx4 v[116:119], v4, s[36:39], s84 offen sc1
    ds_write_b128 v9, v[84:87] offset:8192
    ds_write_b128 v9, v[88:91] offset:9216
    ds_write_b128 v9, v[92:95] offset:10240
    ds_write_b128 v9, v[96:99] offset:11264
    s_waitcnt vmcnt(5)
E_chk23:
    v_max_u32 v7, v40, v43
    v_cmp_eq_u32 vcc, -1, v7
    s_cbranch_vccnz E_retry23
E_go23:
    v_mfma_f32_16x16x32_bf16 v[100:103], v[40:43], a[32:35], v[100:103]
    v_mfma_f32_16x16x32_bf16 v[104:107], v[40:43], a[36:39], v[104:107]
    v_mfma_f32_16x16x32_bf16 v[108:111], v[40:43], a[40:43], v[108:111]
    v_mfma_f32_16x16x32_bf16 v[112:115], v[40:43], a[44:47], v[112:115]
    s_waitcnt vmcnt(4)
E_chk24:
    v_max_u32 v7, v20, v23
    v_cmp_eq_u32 vcc, -1, v7
    s_cbranch_vccnz E_retry24
E_go24:
    v_mfma_f32_16x16x32_bf16 v[100:103], v[20:23], a[48:51], v[100:103]
    v_mfma_f32_16x16x32_bf16 v[104:107], v[20:23], a[52:55], v[104:107]
    v_mfma_f32_16x16x32_bf16 v[108:111], v[20:23], a[56:59], v[108:111]
    v_mfma_f32_16x16x32_bf16 v[112:115], v[20:23], a[60:63], v[112:115]
    s_waitcnt vmcnt(3)
E_chk25:
    v_max_u32 v7, v24, v27
    v_cmp_eq_u32 vcc, -1, v7
    s_cbranch_vccnz E_retry25
E_go25:
    v_mfma_f32_16x16x32_bf16 v[100:103], v[24:27], a[64:67], v[100:103]
    v_mfma_f32_16x16x32_bf16 v[104:107], v[24:27], a[68:71], v[104:107]
    v_mfma_f32_16x16x32_bf16 v[108:111], v[24:27], a[72:75], v[108:111]
    v_mfma_f32_16x16x32_bf16 v[112:115], v[24:27], a[76:79], v[112:115]
    s_waitcnt vmcnt(2)
E_chk26:
    v_max_u32 v7, v28, v31
    v_cmp_eq_u32 vcc, -1, v7
    s_cbranch_vccnz E_retry26
E_go26:
    v_mfma_f32_16x16x32_bf16 v[100:103], v[28:31], a[80:83], v[100:103]
    v_mfma_f32_16x16x32_bf16 v[104:107], v[28:31], a[84:87], v[104:107]
    v_mfma_f32_16x16x32_bf16 v[108:111], v[28:31], a[88:91], v[108:111]
    v_mfma_f32_16x16x32_bf16 v[112:115], v[28:31], a[92:95], v[112:115]
    s_waitcnt vmcnt(1)
E_chk27:
    v_max_u32 v7, v32, v35
    v_cmp_eq_u32 vcc, -1, v7
    s_cbranch_vccnz E_retry27
E_go27:
    v_mfma_f32_16x16x32_bf16 v[100:103], v[32:35], a[96:99], v[100:103]
    v_mfma_f32_16x16x32_bf16 v[104:107], v[32:35], a[100:103], v[104:107]
    v_mfma_f32_16x16x32_bf16 v[108:111], v[32:35], a[104:107], v[108:111]
    v_mfma_f32_16x16x32_bf16 v[112:115], v[32:35], a[108:111], v[112:115]
    s_nop 4
    ds_write_b128 v9, v[100:103] offset:12288
    ds_write_b128 v9, v[104:107] offset:13312
    ds_write_b128 v9, v[108:111] offset:14336
    ds_write_b128 v9, v[112:115] offset:15360
    v_add_u32 v19, 65536, v11
    s_waitcnt lgkmcnt(0)
    s_barrier
    ds_read_b128 v[20:23], v11 offset:0
    ds_read_b128 v[24:27], v11 offset:4096
    ds_read_b128 v[28:31], v11 offset:16384
    ds_read_b128 v[32:35], v11 offset:20480
    ds_read_b128 v[36:39], v11 offset:32768
    ds_read_b128 v[40:43], v11 offset:36864
    ds_read_b128 v[44:47], v11 offset:49152
    ds_read_b128 v[48:51], v11 offset:53248
    ds_read_b128 v[52:55], v19 offset:0
    ds_read_b128 v[56:59], v19 offset:4096
    ds_read_b128 v[60:63], v19 offset:16384
    ds_read_b128 v[64:67], v19 offset:20480
    ds_read_b128 v[68:71], v19 offset:32768
    ds_read_b128 v[72:75], v19 offset:36864
    ds_read_b128 v[76:79], v19 offset:49152
    ds_read_b128 v[80:83], v19 offset:53248
    s_waitcnt lgkmcnt(12)
    v_pk_add_f32 v[20:21], v[20:21], v[28:29]
    v_pk_add_f32 v[22:23], v[22:23], v[30:31]
    v_pk_add_f32 v[24:25], v[24:25], v[32:33]
    v_pk_add_f32 v[26:27], v[26:27], v[34:35]
    s_waitcnt lgkmcnt(8)
    v_pk_add_f32 v[36:37], v[36:37], v[44:45]
    v_pk_add_f32 v[38:39], v[38:39], v[46:47]
    v_pk_add_f32 v[40:41], v[40:41], v[48:49]
    v_pk_add_f32 v[42:43], v[42:43], v[50:51]
    v_pk_add_f32 v[20:21], v[20:21], v[36:37]
    v_pk_add_f32 v[22:23], v[22:23], v[38:39]
    v_pk_add_f32 v[24:25], v[24:25], v[40:41]
    v_pk_add_f32 v[26:27], v[26:27], v[42:43]
    s_waitcnt lgkmcnt(4)
    v_pk_add_f32 v[52:53], v[52:53], v[60:61]
    v_pk_add_f32 v[54:55], v[54:55], v[62:63]
    v_pk_add_f32 v[56:57], v[56:57], v[64:65]
    v_pk_add_f32 v[58:59], v[58:59], v[66:67]
    s_waitcnt lgkmcnt(0)
    v_pk_add_f32 v[68:69], v[68:69], v[76:77]
    v_pk_add_f32 v[70:71], v[70:71], v[78:79]
    v_pk_add_f32 v[72:73], v[72:73], v[80:81]
    v_pk_add_f32 v[74:75], v[74:75], v[82:83]
    v_pk_add_f32 v[52:53], v[52:53], v[68:69]
    v_pk_add_f32 v[54:55], v[54:55], v[70:71]
    v_pk_add_f32 v[56:57], v[56:57], v[72:73]
    v_pk_add_f32 v[58:59], v[58:59], v[74:75]
    v_pk_add_f32 v[20:21], v[20:21], v[52:53]
    v_pk_add_f32 v[22:23], v[22:23], v[54:55]
    v_pk_add_f32 v[24:25], v[24:25], v[56:57]
    v_pk_add_f32 v[26:27], v[26:27], v[58:59]
    v_cvt_pk_bf16_f32 v21, v20, v21
    v_cvt_pk_bf16_f32 v23, v22, v23
    v_cvt_pk_bf16_f32 v25, v24, v25
    v_cvt_pk_bf16_f32 v27, v26, v27
    v_lshlrev_b32 v20, 16, v21
    v_and_b32 v21, 0xffff0000, v21
    v_lshlrev_b32 v22, 16, v23
    v_and_b32 v23, 0xffff0000, v23
    v_lshlrev_b32 v24, 16, v25
    v_and_b32 v25, 0xffff0000, v25
    v_lshlrev_b32 v26, 16, v27
    v_and_b32 v27, 0xffff0000, v27
    s_waitcnt vmcnt(0)
    v_pk_add_f32 v[20:21], v[20:21], v[120:121] op_sel_hi:[1,0]
    v_pk_add_f32 v[22:23], v[22:23], v[120:121] op_sel_hi:[1,0]
    v_pk_add_f32 v[24:25], v[24:25], v[120:121] op_sel_hi:[1,0]
    v_pk_add_f32 v[26:27], v[26:27], v[120:121] op_sel_hi:[1,0]
    v_cvt_pk_bf16_f32 v21, v20, v21
    v_cvt_pk_bf16_f32 v23, v22, v23
    v_cvt_pk_bf16_f32 v25, v24, v25
    v_cvt_pk_bf16_f32 v27, v26, v27
    v_lshlrev_b32 v20, 16, v21
    v_and_b32 v21, 0xffff0000, v21
    v_lshlrev_b32 v22, 16, v23
    v_and_b32 v23, 0xffff0000, v23
    v_lshlrev_b32 v24, 16, v25
    v_and_b32 v25, 0xffff0000, v25
    v_lshlrev_b32 v26, 16, v27
    v_and_b32 v27, 0xffff0000, v27
    v_lshlrev_b32 v84, 16, v116
    v_and_b32 v85, 0xffff0000, v116
    v_lshlrev_b32 v86, 16, v117
    v_and_b32 v87, 0xffff0000, v117
    v_lshlrev_b32 v88, 16, v118
    v_and_b32 v89, 0xffff0000, v118
    v_lshlrev_b32 v90, 16, v119
    v_and_b32 v91, 0xffff0000, v119
    v_pk_add_f32 v[20:21], v[20:21], v[84:85]
    v_pk_add_f32 v[22:23], v[22:23], v[86:87]
    v_pk_add_f32 v[24:25], v[24:25], v[88:89]
    v_pk_add_f32 v[26:27], v[26:27], v[90:91]
    v_cvt_pk_bf16_f32 v92, v20, v21
    v_cvt_pk_bf16_f32 v93, v22, v23
    v_cvt_pk_bf16_f32 v94, v24, v25
    v_cvt_pk_bf16_f32 v95, v26, v27
    buffer_store_dwordx4 v[92:95], v4, s[64:67], s84 offen
Z_fin:
Z_end:
    s_endpgm
D_retry0:
    s_add_u32 s6, s6, 1
    s_cmp_ge_u32 s6, 1048576
    s_cbranch_scc1 D_go0
    s_add_u32 s7, s88, 0
    buffer_load_dwordx4 v[20:23], v3, s[40:43], s7 offen sc1
    s_waitcnt vmcnt(0)
    s_branch D_chk0
D_retry1:
    s_add_u32 s6, s6, 1
    s_cmp_ge_u32 s6, 1048576
    s_cbranch_scc1 D_go1
    s_add_u32 s7, s88, 1024
    buffer_load_dwordx4 v[24:27], v3, s[40:43], s7 offen sc1
    s_waitcnt vmcnt(0)
    s_branch D_chk1
D_retry2:
    s_add_u32 s6, s6, 1
    s_cmp_ge_u32 s6, 1048576
    s_cbranch_scc1 D_go2
    s_add_u32 s7, s88, 2048
    buffer_load_dwordx4 v[28:31], v3, s[40:43], s7 offen sc1
    s_waitcnt vmcnt(0)
    s_branch D_chk2
D_retry3:
    s_add_u32 s6, s6, 1
    s_cmp_ge_u32 s6, 1048576
    s_cbranch_scc1 D_go3
    s_add_u32 s7, s88, 3072
    buffer_load_dwordx4 v[32:35], v3, s[40:43], s7 offen sc1
    s_waitcnt vmcnt(0)
    s_branch D_chk3
D_retry4:
    s_add_u32 s6, s6, 1
    s_cmp_ge_u32 s6, 1048576
    s_cbranch_scc1 D_go4
    s_add_u32 s7, s88, 4096
    buffer_load_dwordx4 v[36:39], v3, s[40:43], s7 offen sc1
    s_waitcnt vmcnt(0)
    s_branch D_chk4
D_retry5:
    s_add_u32 s6, s6, 1
    s_cmp_ge_u32 s6, 1048576
    s_cbranch_scc1 D_go5
    s_add_u32 s7, s88, 5120
    buffer_load_dwordx4 v[40:43], v3, s[40:43], s7 offen sc1
    s_waitcnt vmcnt(0)
    s_branch D_chk5
D_retry6:
    s_add_u32 s6, s6, 1
    s_cmp_ge_u32 s6, 1048576
    s_cbranch_scc1 D_go6
    s_add_u32 s7, s88, 6144
    buffer_load_dwordx4 v[20:23], v3, s[40:43], s7 offen sc1
    s_waitcnt vmcnt(0)
    s_branch D_chk6
D_retry7:
    s_add_u32 s6, s6, 1
    s_cmp_ge_u32 s6, 1048576
    s_cbranch_scc1 D_go7
    s_add_u32 s7, s88, 7168
    buffer_load_dwordx4 v[24:27], v3, s[40:43], s7 offen sc1
    s_waitcnt vmcnt(0)
    s_branch D_chk7
D_retry8:
    s_add_u32 s6, s6, 1
    s_cmp_ge_u32 s6, 1048576
    s_cbranch_scc1 D_go8
    s_add_u32 s7, s88, 65536
    buffer_load_dwordx4 v[28:31], v3, s[40:43], s7 offen sc1
    s_waitcnt vmcnt(0)
    s_branch D_chk8
D_retry9:
    s_add_u32 s6, s6, 1
    s_cmp_ge_u32 s6, 1048576
    s_cbranch_scc1 D_go9
    s_add_u32 s7, s88, 66560
    buffer_load_dwordx4 v[32:35], v3, s[40:43], s7 offen sc1
    s_waitcnt vmcnt(0)
    s_branch D_chk9
D_retry10:
    s_add_u32 s6, s6, 1
    s_cmp_ge_u32 s6, 1048576
    s_cbranch_scc1 D_go10
    s_add_u32 s7, s88, 67584
    buffer_load_dwordx4 v[36:39], v3, s[40:43], s7 offen sc1
    s_waitcnt vmcnt(0)
    s_branch D_chk10
D_retry11:
    s_add_u32 s6, s6, 1
    s_cmp_ge_u32 s6, 1048576
    s_cbranch_scc1 D_go11
    s_add_u32 s7, s88, 68608
    buffer_load_dwordx4 v[40:43], v3, s[40:43], s7 offen sc1
    s_waitcnt vmcnt(0)
    s_branch D_chk11
D_retry12:
    s_add_u32 s6, s6, 1
    s_cmp_ge_u32 s6, 1048576
    s_cbranch_scc1 D_go12
    s_add_u32 s7, s88, 69632
    buffer_load_dwordx4 v[20:23], v3, s[40:43], s7 offen sc1
    s_waitcnt vmcnt(0)
    s_branch D_chk12
D_retry13:
    s_add_u32 s6, s6, 1
    s_cmp_ge_u32 s6, 1048576
    s_cbranch_scc1 D_go13
    s_add_u32 s7, s88, 70656
    buffer_load_dwordx4 v[24:27], v3, s[40:43], s7 offen sc1
    s_waitcnt vmcnt(0)
    s_branch D_chk13
D_retry14:
    s_add_u32 s6, s6, 1
    s_cmp_ge_u32 s6, 1048576
    s_cbranch_scc1 D_go14
    s_add_u32 s7, s88, 71680
    buffer_load_dwordx4 v[28:31], v3, s[40:43], s7 offen sc1
    s_waitcnt vmcnt(0)
    s_branch D_chk14
D_retry15:
    s_add_u32 s6, s6, 1
    s_cmp_ge_u32 s6, 1048576
    s_cbranch_scc1 D_go15
    s_add_u32 s7, s88, 72704
    buffer_load_dwordx4 v[32:35], v3, s[40:43], s7 offen sc1
    s_waitcnt vmcnt(0)
    s_branch D_chk15
D_retry16:
    s_add_u32 s6, s6, 1
    s_cmp_ge_u32 s6, 1048576
    s_cbranch_scc1 D_go16
    s_add_u32 s7, s88, 131072
    buffer_load_dwordx4 v[36:39], v3, s[40:43], s7 offen sc1
    s_waitcnt vmcnt(0)
    s_branch D_chk16
D_retry17:
    s_add_u32 s6, s6, 1
    s_cmp_ge_u32 s6, 1048576
    s_cbranch_scc1 D_go17
    s_add_u32 s7, s88, 132096
    buffer_load_dwordx4 v[40:43], v3, s[40:43], s7 offen sc1
    s_waitcnt vmcnt(0)
    s_branch D_chk17
D_retry18:
    s_add_u32 s6, s6, 1
    s_cmp_ge_u32 s6, 1048576
    s_cbranch_scc1 D_go18
    s_add_u32 s7, s88, 133120
    buffer_load_dwordx4 v[20:23], v3, s[40:43], s7 offen sc1
    s_waitcnt vmcnt(0)
    s_branch D_chk18
D_retry19:
    s_add_u32 s6, s6, 1
    s_cmp_ge_u32 s6, 1048576
    s_cbranch_scc1 D_go19
    s_add_u32 s7, s88, 134144
    buffer_load_dwordx4 v[24:27], v3, s[40:43], s7 offen sc1
    s_waitcnt vmcnt(0)
    s_branch D_chk19
D_retry20:
    s_add_u32 s6, s6, 1
    s_cmp_ge_u32 s6, 1048576
    s_cbranch_scc1 D_go20
    s_add_u32 s7, s88, 135168
    buffer_load_dwordx4 v[28:31], v3, s[40:43], s7 offen sc1
    s_waitcnt vmcnt(0)
    s_branch D_chk20
D_retry21:
    s_add_u32 s6, s6, 1
    s_cmp_ge_u32 s6, 1048576
    s_cbranch_scc1 D_go21
    s_add_u32 s7, s88, 136192
    buffer_load_dwordx4 v[32:35], v3, s[40:43], s7 offen sc1
    s_waitcnt vmcnt(0)
    s_branch D_chk21
D_retry22:
    s_add_u32 s6, s6, 1
    s_cmp_ge_u32 s6, 1048576
    s_cbranch_scc1 D_go22
    s_add_u32 s7, s88, 137216
    buffer_load_dwordx4 v[36:39], v3, s[40:43], s7 offen sc1
    s_waitcnt vmcnt(0)
    s_branch D_chk22
D_retry23:
    s_add_u32 s6, s6, 1
    s_cmp_ge_u32 s6, 1048576
    s_cbranch_scc1 D_go23
    s_add_u32 s7, s88, 138240
    buffer_load_dwordx4 v[40:43], v3, s[40:43], s7 offen sc1
    s_waitcnt vmcnt(0)
    s_branch D_chk23
D_retry24:
    s_add_u32 s6, s6, 1
    s_cmp_ge_u32 s6, 1048576
    s_cbranch_scc1 D_go24
    s_add_u32 s7, s88, 196608
    buffer_load_dwordx4 v[20:23], v3, s[40:43], s7 offen sc1
    s_waitcnt vmcnt(0)
    s_branch D_chk24
D_retry25:
    s_add_u32 s6, s6, 1
    s_cmp_ge_u32 s6, 1048576
    s_cbranch_scc1 D_go25
    s_add_u32 s7, s88, 197632
    buffer_load_dwordx4 v[24:27], v3, s[40:43], s7 offen sc1
    s_waitcnt vmcnt(0)
    s_branch D_chk25
D_retry26:
    s_add_u32 s6, s6, 1
    s_cmp_ge_u32 s6, 1048576
    s_cbranch_scc1 D_go26
    s_add_u32 s7, s88, 198656
    buffer_load_dwordx4 v[28:31], v3, s[40:43], s7 offen sc1
    s_waitcnt vmcnt(0)
    s_branch D_chk26
D_retry27:
    s_add_u32 s6, s6, 1
    s_cmp_ge_u32 s6, 1048576
    s_cbranch_scc1 D_go27
    s_add_u32 s7, s88, 199680
    buffer_load_dwordx4 v[32:35], v3, s[40:43], s7 offen sc1
    s_waitcnt vmcnt(0)
    s_branch D_chk27
D_retry28:
    s_add_u32 s6, s6, 1
    s_cmp_ge_u32 s6, 1048576
    s_cbranch_scc1 D_go28
    s_add_u32 s7, s88, 200704
    buffer_load_dwordx4 v[36:39], v3, s[40:43], s7 offen sc1
    s_waitcnt vmcnt(0)
    s_branch D_chk28
D_retry29:
    s_add_u32 s6, s6, 1
    s_cmp_ge_u32 s6, 1048576
    s_cbranch_scc1 D_go29
    s_add_u32 s7, s88, 201728
    buffer_load_dwordx4 v[40:43], v3, s[40:43], s7 offen sc1
    s_waitcnt vmcnt(0)
    s_branch D_chk29
D_retry30:
    s_add_u32 s6, s6, 1
    s_cmp_ge_u32 s6, 1048576
    s_cbranch_scc1 D_go30
    s_add_u32 s7, s88, 202752
    buffer_load_dwordx4 v[20:23], v3, s[40:43], s7 offen sc1
    s_waitcnt vmcnt(0)
    s_branch D_chk30
D_retry31:
    s_add_u32 s6, s6, 1
    s_cmp_ge_u32 s6, 1048576
    s_cbranch_scc1 D_go31
    s_add_u32 s7, s88, 203776
    buffer_load_dwordx4 v[24:27], v3, s[40:43], s7 offen sc1
    s_waitcnt vmcnt(0)
    s_branch D_chk31
E_retry0:
    s_add_u32 s6, s6, 1
    s_cmp_ge_u32 s6, 1048576
    s_cbranch_scc1 E_go0
    s_add_u32 s7, s88, 0
    buffer_load_dwordx4 v[20:23], v3, s[44:47], s7 offen sc1
    s_waitcnt vmcnt(0)
    s_branch E_chk0
E_retry1:
    s_add_u32 s6, s6, 1
    s_cmp_ge_u32 s6, 1048576
    s_cbranch_scc1 E_go1
    s_add_u32 s7, s88, 1024
    buffer_load_dwordx4 v[24:27], v3, s[44:47], s7 offen sc1
    s_waitcnt vmcnt(0)
    s_branch E_chk1
E_retry2:
    s_add_u32 s6, s6, 1
    s_cmp_ge_u32 s6, 1048576
    s_cbranch_scc1 E_go2
    s_add_u32 s7, s88, 2048
    buffer_load_dwordx4 v[28:31], v3, s[44:47], s7 offen sc1
    s_waitcnt vmcnt(0)
    s_branch E_chk2
E_retry3:
    s_add_u32 s6, s6, 1
    s_cmp_ge_u32 s6, 1048576
    s_cbranch_scc1 E_go3
    s_add_u32 s7, s88, 3072
    buffer_load_dwordx4 v[32:35], v3, s[44:47], s7 offen sc1
    s_waitcnt vmcnt(0)
    s_branch E_chk3
E_retry4:
    s_add_u32 s6, s6, 1
    s_cmp_ge_u32 s6, 1048576
    s_cbranch_scc1 E_go4
    s_add_u32 s7, s88, 4096
    buffer_load_dwordx4 v[36:39], v3, s[44:47], s7 offen sc1
    s_waitcnt vmcnt(0)
    s_branch E_chk4
E_retry5:
    s_add_u32 s6, s6, 1
    s_cmp_ge_u32 s6, 1048576
    s_cbranch_scc1 E_go5
    s_add_u32 s7, s88, 5120
    buffer_load_dwordx4 v[40:43], v3, s[44:47], s7 offen sc1
    s_waitcnt vmcnt(0)
    s_branch E_chk5
E_retry6:
    s_add_u32 s6, s6, 1
    s_cmp_ge_u32 s6, 1048576
    s_cbranch_scc1 E_go6
    s_add_u32 s7, s88, 6144
    buffer_load_dwordx4 v[20:23], v3, s[44:47], s7 offen sc1
    s_waitcnt vmcnt(0)
    s_branch E_chk6
E_retry7:
    s_add_u32 s6, s6, 1
    s_cmp_ge_u32 s6, 1048576
    s_cbranch_scc1 E_go7
    s_add_u32 s7, s88, 57344
    buffer_load_dwordx4 v[24:27], v3, s[44:47], s7 offen sc1
    s_waitcnt vmcnt(0)
    s_branch E_chk7
E_retry8:
    s_add_u32 s6, s6, 1
    s_cmp_ge_u32 s6, 1048576
    s_cbranch_scc1 E_go8
    s_add_u32 s7, s88, 58368
    buffer_load_dwordx4 v[28:31], v3, s[44:47], s7 offen sc1
    s_waitcnt vmcnt(0)
    s_branch E_chk8
E_retry9:
    s_add_u32 s6, s6, 1
    s_cmp_ge_u32 s6, 1048576
    s_cbranch_scc1 E_go9
    s_add_u32 s7, s88, 59392
    buffer_load_dwordx4 v[32:35], v3, s[44:47], s7 offen sc1
    s_waitcnt vmcnt(0)
    s_branch E_chk9
E_retry10:
    s_add_u32 s6, s6, 1
    s_cmp_ge_u32 s6, 1048576
    s_cbranch_scc1 E_go10
    s_add_u32 s7, s88, 60416
    buffer_load_dwordx4 v[36:39], v3, s[44:47], s7 offen sc1
    s_waitcnt vmcnt(0)
    s_branch E_chk10
E_retry11:
    s_add_u32 s6, s6, 1
    s_cmp_ge_u32 s6, 1048576
    s_cbranch_scc1 E_go11
    s_add_u32 s7, s88, 61440
    buffer_load_dwordx4 v[40:43], v3, s[44:47], s7 offen sc1
    s_waitcnt vmcnt(0)
    s_branch E_chk11
E_retry12:
    s_add_u32 s6, s6, 1
    s_cmp_ge_u32 s6, 1048576
    s_cbranch_scc1 E_go12
    s_add_u32 s7, s88, 62464
    buffer_load_dwordx4 v[20:23], v3, s[44:47], s7 offen sc1
    s_waitcnt vmcnt(0)
    s_branch E_chk12
E_retry13:
    s_add_u32 s6, s6, 1
    s_cmp_ge_u32 s6, 1048576
    s_cbranch_scc1 E_go13
    s_add_u32 s7, s88, 63488
    buffer_load_dwordx4 v[24:27], v3, s[44:47], s7 offen sc1
    s_waitcnt vmcnt(0)
    s_branch E_chk13
E_retry14:
    s_add_u32 s6, s6, 1
    s_cmp_ge_u32 s6, 1048576
    s_cbranch_scc1 E_go14
    s_add_u32 s7, s88, 114688
    buffer_load_dwordx4 v[28:31], v3, s[44:47], s7 offen sc1
    s_waitcnt vmcnt(0)
    s_branch E_chk14
E_retry15:
    s_add_u32 s6, s6, 1
    s_cmp_ge_u32 s6, 1048576
    s_cbranch_scc1 E_go15
    s_add_u32 s7, s88, 115712
    buffer_load_dwordx4 v[32:35], v3, s[44:47], s7 offen sc1
    s_waitcnt vmcnt(0)
    s_branch E_chk15
E_retry16:
    s_add_u32 s6, s6, 1
    s_cmp_ge_u32 s6, 1048576
    s_cbranch_scc1 E_go16
    s_add_u32 s7, s88, 116736
    buffer_load_dwordx4 v[36:39], v3, s[44:47], s7 offen sc1
    s_waitcnt vmcnt(0)
    s_branch E_chk16
E_retry17:
    s_add_u32 s6, s6, 1
    s_cmp_ge_u32 s6, 1048576
    s_cbranch_scc1 E_go17
    s_add_u32 s7, s88, 117760
    buffer_load_dwordx4 v[40:43], v3, s[44:47], s7 offen sc1
    s_waitcnt vmcnt(0)
    s_branch E_chk17
E_retry18:
    s_add_u32 s6, s6, 1
    s_cmp_ge_u32 s6, 1048576
    s_cbranch_scc1 E_go18
    s_add_u32 s7, s88, 118784
    buffer_load_dwordx4 v[20:23], v3, s[44:47], s7 offen sc1
    s_waitcnt vmcnt(0)
    s_branch E_chk18
E_retry19:
    s_add_u32 s6, s6, 1
    s_cmp_ge_u32 s6, 1048576
    s_cbranch_scc1 E_go19
    s_add_u32 s7, s88, 119808
    buffer_load_dwordx4 v[24:27], v3, s[44:47], s7 offen sc1
    s_waitcnt vmcnt(0)
    s_branch E_chk19
E_retry20:
    s_add_u32 s6, s6, 1
    s_cmp_ge_u32 s6, 1048576
    s_cbranch_scc1 E_go20
    s_add_u32 s7, s88, 120832
    buffer_load_dwordx4 v[28:31], v3, s[44:47], s7 offen sc1
    s_waitcnt vmcnt(0)
    s_branch E_chk20
E_retry21:
    s_add_u32 s6, s6, 1
    s_cmp_ge_u32 s6, 1048576
    s_cbranch_scc1 E_go21
    s_add_u32 s7, s88, 172032
    buffer_load_dwordx4 v[32:35], v3, s[44:47], s7 offen sc1
    s_waitcnt vmcnt(0)
    s_branch E_chk21
E_retry22:
    s_add_u32 s6, s6, 1
    s_cmp_ge_u32 s6, 1048576
    s_cbranch_scc1 E_go22
    s_add_u32 s7, s88, 173056
    buffer_load_dwordx4 v[36:39], v3, s[44:47], s7 offen sc1
    s_waitcnt vmcnt(0)
    s_branch E_chk22
E_retry23:
    s_add_u32 s6, s6, 1
    s_cmp_ge_u32 s6, 1048576
    s_cbranch_scc1 E_go23
    s_add_u32 s7, s88, 174080
    buffer_load_dwordx4 v[40:43], v3, s[44:47], s7 offen sc1
    s_waitcnt vmcnt(0)
    s_branch E_chk23
E_retry24:
    s_add_u32 s6, s6, 1
    s_cmp_ge_u32 s6, 1048576
    s_cbranch_scc1 E_go24
    s_add_u32 s7, s88, 175104
    buffer_load_dwordx4 v[20:23], v3, s[44:47], s7 offen sc1
    s_waitcnt vmcnt(0)
    s_branch E_chk24
E_retry25:
    s_add_u32 s6, s6, 1
    s_cmp_ge_u32 s6, 1048576
    s_cbranch_scc1 E_go25
    s_add_u32 s7, s88, 176128
    buffer_load_dwordx4 v[24:27], v3, s[44:47], s7 offen sc1
    s_waitcnt vmcnt(0)
    s_branch E_chk25
E_retry26:
    s_add_u32 s6, s6, 1
    s_cmp_ge_u32 s6, 1048576
    s_cbranch_scc1 E_go26
    s_add_u32 s7, s88, 177152
    buffer_load_dwordx4 v[28:31], v3, s[44:47], s7 offen sc1
    s_waitcnt vmcnt(0)
    s_branch E_chk26
E_retry27:
    s_add_u32 s6, s6, 1
    s_cmp_ge_u32 s6, 1048576
    s_cbranch_scc1 E_go27
    s_add_u32 s7, s88, 178176
    buffer_load_dwordx4 v[32:35], v3, s[44:47], s7 offen sc1
    s_waitcnt vmcnt(0)
    s_branch E_chk27
code_end:
.section .rodata,"a"
.p2align 6
.amdhsa_kernel sequential_preLN__spectral_gfnet__mixer_token_mlp__prompt_kernel
  .amdhsa_next_free_vgpr 256
  .amdhsa_next_free_sgpr 102
  .amdhsa_accum_offset 128
  .amdhsa_group_segment_fixed_size 0
  .amdhsa_kernarg_size 88
  .amdhsa_user_sgpr_count 2
  .amdhsa_user_sgpr_kernarg_segment_ptr 1
  .amdhsa_system_sgpr_workgroup_id_x 1
  .amdhsa_float_denorm_mode_32 3
  .amdhsa_float_denorm_mode_16_64 3
.end_amdhsa_kernel
.p2align 8
tables:
.long 0x320c320c,0x320c320c,0x320c320c,0x320c320c,0x31e5320c,0x30ba3173,0xb0bab173,0xad3faf8b
.long 0x3173320c,0x29622f8b,0x29622f8b,0xaf8ba962,0x30ba320c,0xad3f2962,0x2d3fa962,0x31e53173
.long 0x2f8b320c,0xb173a962,0xb173a962,0xa962b173,0x2d3f320c,0xb1e5af8b,0x31e52f8b,0xb0ba2962
.long 0x2962320c,0xaf8bb173,0xaf8bb173,0x31732f8b,0x0000320c,0x8000b20c,0x0000320c,0x8000b20c
.long 0xa962320c,0x2f8bb173,0x2f8bb173,0xb1732f8b,0xad3f320c,0x31e5af8b,0xb1e52f8b,0x30ba2962
.long 0xaf8b320c,0x3173a962,0x3173a962,0x2962b173,0xb0ba320c,0x2d3f2962,0xad3fa962,0xb1e53173
.long 0xb173320c,0xa9622f8b,0xa9622f8b,0x2f8ba962,0xb1e5320c,0xb0ba3173,0x30bab173,0x2d3faf8b
.long 0xb20c320c,0xb20c320c,0xb20c320c,0xb20c320c,0x00000000,0x00000000,0x00000000,0x00000000
.long 0x320c320c,0x320c320c,0x320c320c,0x320c320c,0x2d3f2f8b,0x00002962,0x8000a962,0x2d3f2962
.long 0xaf8ba962,0xb20cb173,0xb20cb173,0xaf8bb173,0xb1e5b173,0x8000af8b,0x00002f8b,0xb1e5af8b
.long 0xa962b173,0x320c2f8b,0x320c2f8b,0xa9622f8b,0x30baa962,0x00003173,0x8000b173,0x30ba3173
.long 0x31732f8b,0xb20ca962,0xb20ca962,0x3173a962,0x0000320c,0x8000b20c,0x0000320c,0x8000b20c
.long 0xb1732f8b,0x320ca962,0x320ca962,0xb173a962,0xb0baa962,0x00003173,0x8000b173,0xb0ba3173
.long 0x2962b173,0xb20c2f8b,0xb20c2f8b,0x29622f8b,0x31e5b173,0x8000af8b,0x00002f8b,0x31e5af8b
.long 0x2f8ba962,0x320cb173,0x320cb173,0x2f8bb173,0xad3f2f8b,0x00002962,0x8000a962,0xad3f2962
.long 0xb20c320c,0xb20c320c,0xb20c320c,0xb20c320c,0x00000000,0x00000000,0x00000000,0x00000000
.long 0x320c320c,0x320c320c,0x320c320c,0x320c320c,0xad3fa962,0xb0baaf8b,0x30ba2f8b,0x31e53173
.long 0xaf8bb173,0x2962a962,0x2962a962,0x31732f8b,0x31e52f8b,0x2d3f3173,0xad3fb173,0x30ba2962
.long 0xa9622f8b,0xb173b173,0xb173b173,0x2f8ba962,0xb0bab173,0x31e52962,0xb1e5a962,0x2d3faf8b
.long 0x3173a962,0xaf8b2f8b,0xaf8b2f8b,0x2962b173,0x0000320c,0x8000b20c,0x0000320c,0x8000b20c
.long 0xb173a962,0x2f8b2f8b,0x2f8b2f8b,0xa962b173,0x30bab173,0xb1e52962,0x31e5a962,0xad3faf8b
.long 0x29622f8b,0x3173b173,0x3173b173,0xaf8ba962,0xb1e52f8b,0xad3f3173,0x2d3fb173,0xb0ba2962
.long 0x2f8bb173,0xa962a962,0xa962a962,0xb1732f8b,0x2d3fa962,0x30baaf8b,0xb0ba2f8b,0xb1e53173
.long 0xb20c320c,0xb20c320c,0xb20c320c,0xb20c320c,0x00000000,0x00000000,0x00000000,0x00000000
.long 0x320c320c,0x320c320c,0x00000000,0x00000000,0xb1e5b173,0xb1e5b20c,0x00000000,0x00000000
.long 0x31732f8b,0x3173320c,0x00000000,0x00000000,0xb0baa962,0xb0bab20c,0x00000000,0x00000000
.long 0x2f8ba962,0x2f8b320c,0x00000000,0x00000000,0xad3f2f8b,0xad3fb20c,0x00000000,0x00000000
.long 0x2962b173,0x2962320c,0x00000000,0x00000000,0x0000320c,0x8000b20c,0x00000000,0x00000000
.long 0xa962b173,0xa962320c,0x00000000,0x00000000,0x2d3f2f8b,0x2d3fb20c,0x00000000,0x00000000
.long 0xaf8ba962,0xaf8b320c,0x00000000,0x00000000,0x30baa962,0x30bab20c,0x00000000,0x00000000
.long 0xb1732f8b,0xb173320c,0x00000000,0x00000000,0x31e5b173,0x31e5b20c,0x00000000,0x00000000
.long 0xb20c320c,0xb20c320c,0x00000000,0x00000000,0x00000000,0x00000000,0x00000000,0x00000000
.long 0x80008000,0x80008000,0x80008000,0x80008000,0xa9628000,0xaf8bad3f,0x2f8b2d3f,0x317330ba
.long 0xad3f8000,0xb1e5b0ba,0xb1e5b0ba,0xb0bab1e5,0xaf8b8000,0xb173b1e5,0x317331e5,0xa9622d3f
.long 0xb0ba8000,0xad3fb1e5,0xad3fb1e5,0x31e52d3f,0xb1738000,0x2962b0ba,0xa96230ba,0xaf8bb1e5
.long 0xb1e58000,0x30baad3f,0x30baad3f,0xad3f30ba,0xb20c8000,0x320c8000,0xb20c8000,0x320c8000
.long 0xb1e58000,0x30ba2d3f,0x30ba2d3f,0xad3fb0ba,0xb1738000,0x296230ba,0xa962b0ba,0xaf8b31e5
.long 0xb0ba8000,0xad3f31e5,0xad3f31e5,0x31e5ad3f,0xaf8b8000,0xb17331e5,0x3173b1e5,0xa962ad3f
.long 0xad3f8000,0xb1e530ba,0xb1e530ba,0xb0ba31e5,0xa9628000,0xaf8b2d3f,0x2f8bad3f,0x3173b0ba
.long 0x80008000,0x80008000,0x80008000,0x80008000,0x00000000,0x00000000,0x00000000,0x00000000
.long 0x80008000,0x80008000,0x80008000,0x80008000,0xb173b0ba,0xb20cb1e5,0x320c31e5,0x317331e5
.long 0xb0bab1e5,0x8000ad3f,0x8000ad3f,0x30ba2d3f,0x2962ad3f,0x320c30ba,0xb20cb0ba,0xa962b0ba
.long 0x31e52d3f,0x800030ba,0x800030ba,0xb1e5b0ba,0x2f8b31e5,0xb20cad3f,0x320c2d3f,0xaf8b2d3f
.long 0xad3f30ba,0x8000b1e5,0x8000b1e5,0x2d3f31e5,0xb20c8000,0x320c8000,0xb20c8000,0x320c8000
.long 0xad3fb0ba,0x800031e5,0x800031e5,0x2d3fb1e5,0x2f8bb1e5,0xb20c2d3f,0x320cad3f,0xaf8bad3f
.long 0x31e5ad3f,0x8000b0ba,0x8000b0ba,0xb1e530ba,0x29622d3f,0x320cb0ba,0xb20c30ba,0xa96230ba
.long 0xb0ba31e5,0x80002d3f,0x80002d3f,0x30baad3f,0xb17330ba,0xb20c31e5,0x320cb1e5,0x3173b1e5
.long 0x80008000,0x80008000,0x80008000,0x80008000,0x00000000,0x00000000,0x00000000,0x00000000
.long 0x80008000,0x80008000,0x80008000,0x80008000,0xb173b1e5,0xaf8bb0ba,0x2f8b30ba,0x29622d3f
.long 0x30ba2d3f,0x31e531e5,0x31e531e5,0x2d3f30ba,0x296230ba,0xb173ad3f,0x31732d3f,0x2f8b31e5
.long 0xb1e5b0ba,0x2d3fad3f,0x2d3fad3f,0x30ba31e5,0x2f8bad3f,0x296231e5,0xa962b1e5,0x317330ba
.long 0x2d3f31e5,0xb0bab0ba,0xb0bab0ba,0x31e52d3f,0xb20c8000,0x320c8000,0xb20c8000,0x320c8000
.long 0x2d3fb1e5,0xb0ba30ba,0xb0ba30ba,0x31e5ad3f,0x2f8b2d3f,0x2962b1e5,0xa96231e5,0x3173b0ba
.long 0xb1e530ba,0x2d3f2d3f,0x2d3f2d3f,0x30bab1e5,0x2962b0ba,0xb1732d3f,0x3173ad3f,0x2f8bb1e5
.long 0x30baad3f,0x31e5b1e5,0x31e5b1e5,0x2d3fb0ba,0xb17331e5,0xaf8b30ba,0x2f8bb0ba,0x2962ad3f
.long 0x80008000,0x80008000,0x80008000,0x80008000,0x00000000,0x00000000,0x00000000,0x00000000
.long 0x80008000,0x80008000,0x00000000,0x00000000,0xa962ad3f,0x29628000,0x00000000,0x00000000
.long 0x2d3f30ba,0xad3f8000,0x00000000,0x00000000,0xaf8bb1e5,0x2f8b8000,0x00000000,0x00000000
.long 0x30ba31e5,0xb0ba8000,0x00000000,0x00000000,0xb173b0ba,0x31738000,0x00000000,0x00000000
.long 0x31e52d3f,0xb1e58000,0x00000000,0x00000000,0xb20c8000,0x320c8000,0x00000000,0x00000000
.long 0x31e5ad3f,0xb1e58000,0x00000000,0x00000000,0xb17330ba,0x31738000,0x00000000,0x00000000
.long 0x30bab1e5,0xb0ba8000,0x00000000,0x00000000,0xaf8b31e5,0x2f8b8000,0x00000000,0x00000000
.long 0x2d3fb0ba,0xad3f8000,0x00000000,0x00000000,0xa9622d3f,0x29628000,0x00000000,0x00000000
.long 0x80008000,0x80008000,0x00000000,0x00000000,0x00000000,0x00000000,0x00000000,0x00000000
.long 0x00003400,0x00003400,0x00003400,0x00003400,0x00003400,0x2e1f3364,0x31a831a8,0x33642e1f
.long 0x00003400,0x31a831a8,0x34000000,0x31a8b1a8,0x00003400,0x33642e1f,0x31a8b1a8,0xae1fb364
.long 0x00003400,0x34000000,0x0000b400,0xb4008000,0x00003400,0x3364ae1f,0xb1a8b1a8,0xae1f3364
.long 0x00003400,0x31a8b1a8,0xb4008000,0x31a831a8,0x00003400,0x2e1fb364,0xb1a831a8,0x3364ae1f
.long 0x00003400,0x0000b400,0x00003400,0x0000b400,0x00003400,0xae1fb364,0x31a831a8,0xb364ae1f
.long 0x00003400,0xb1a8b1a8,0x34000000,0xb1a831a8,0x00003400,0xb364ae1f,0x31a8b1a8,0x2e1f3364
.long 0x00003400,0xb4008000,0x0000b400,0x34000000,0x00003400,0xb3642e1f,0xb1a8b1a8,0x2e1fb364
.long 0x00003400,0xb1a831a8,0xb4008000,0xb1a8b1a8,0x00003400,0xae1f3364,0xb1a831a8,0xb3642e1f
.long 0x00003400,0x00003400,0x00003400,0x00003400,0x34000000,0x3364ae1f,0x31a8b1a8,0x2e1fb364
.long 0x0000b400,0xb1a8b1a8,0xb4008000,0xb1a831a8,0xb4008000,0xae1f3364,0x31a831a8,0x3364ae1f
.long 0x00003400,0x34000000,0x0000b400,0xb4008000,0x34000000,0xae1fb364,0xb1a831a8,0x33642e1f
.long 0x0000b400,0xb1a831a8,0x34000000,0xb1a8b1a8,0xb4008000,0x33642e1f,0xb1a8b1a8,0x2e1f3364
.long 0x00003400,0x0000b400,0x00003400,0x0000b400,0x34000000,0xb3642e1f,0x31a8b1a8,0xae1f3364
.long 0x0000b400,0x31a831a8,0xb4008000,0x31a8b1a8,0xb4008000,0x2e1fb364,0x31a831a8,0xb3642e1f
.long 0x00003400,0xb4008000,0x0000b400,0x34000000,0x34000000,0x2e1f3364,0xb1a831a8,0xb364ae1f
.long 0x0000b400,0x31a8b1a8,0x34000000,0x31a831a8,0xb4008000,0xb364ae1f,0xb1a8b1a8,0xae1fb364
.long 0x00003400,0x00003400,0x00003400,0x00003400,0x0000b400,0xae1fb364,0xb1a8b1a8,0xb364ae1f
.long 0x00003400,0x31a831a8,0x34000000,0x31a8b1a8,0x0000b400,0xb364ae1f,0xb1a831a8,0x2e1f3364
.long 0x00003400,0x34000000,0x0000b400,0xb4008000,0x0000b400,0xb3642e1f,0x31a831a8,0x2e1fb364
.long 0x00003400,0x31a8b1a8,0xb4008000,0x31a831a8,0x0000b400,0xae1f3364,0x31a8b1a8,0xb3642e1f
.long 0x00003400,0x0000b400,0x00003400,0x0000b400,0x0000b400,0x2e1f3364,0xb1a8b1a8,0x33642e1f
.long 0x00003400,0xb1a8b1a8,0x34000000,0xb1a831a8,0x0000b400,0x33642e1f,0xb1a831a8,0xae1fb364
.long 0x00003400,0xb4008000,0x0000b400,0x34000000,0x0000b400,0x3364ae1f,0x31a831a8,0xae1f3364
.long 0x00003400,0xb1a831a8,0xb4008000,0xb1a8b1a8,0x0000b400,0x2e1fb364,0x31a8b1a8,0x3364ae1f
.long 0x00003400,0x00003400,0x00003400,0x00003400,0xb4008000,0xb3642e1f,0xb1a831a8,0xae1f3364
.long 0x0000b400,0xb1a8b1a8,0xb4008000,0xb1a831a8,0x34000000,0x2e1fb364,0xb1a8b1a8,0xb3642e1f
.long 0x00003400,0x34000000,0x0000b400,0xb4008000,0xb4008000,0x2e1f3364,0x31a8b1a8,0xb364ae1f
.long 0x0000b400,0xb1a831a8,0x34000000,0xb1a8b1a8,0x34000000,0xb364ae1f,0x31a831a8,0xae1fb364
.long 0x00003400,0x0000b400,0x00003400,0x0000b400,0xb4008000,0x3364ae1f,0xb1a831a8,0x2e1fb364
.long 0x0000b400,0x31a831a8,0xb4008000,0x31a8b1a8,0x34000000,0xae1f3364,0xb1a8b1a8,0x3364ae1f
.long 0x00003400,0xb4008000,0x0000b400,0x34000000,0xb4008000,0xae1fb364,0x31a8b1a8,0x33642e1f
.long 0x0000b400,0x31a8b1a8,0x34000000,0x31a831a8,0x34000000,0x33642e1f,0x31a831a8,0x2e1f3364
.long 0x34008000,0x34008000,0x34008000,0x34008000,0x34008000,0x3364ae1f,0x31a8b1a8,0x2e1fb364
.long 0x34008000,0x31a8b1a8,0x0000b400,0xb1a8b1a8,0x34008000,0x2e1fb364,0xb1a8b1a8,0xb3642e1f
.long 0x34008000,0x0000b400,0xb4008000,0x80003400,0x34008000,0xae1fb364,0xb1a831a8,0x33642e1f
.long 0x34008000,0xb1a8b1a8,0x80003400,0x31a8b1a8,0x34008000,0xb364ae1f,0x31a831a8,0xae1fb364
.long 0x34008000,0xb4008000,0x34008000,0xb4008000,0x34008000,0xb3642e1f,0x31a8b1a8,0xae1f3364
.long 0x34008000,0xb1a831a8,0x0000b400,0x31a831a8,0x34008000,0xae1f3364,0xb1a8b1a8,0x3364ae1f
.long 0x34008000,0x80003400,0xb4008000,0x0000b400,0x34008000,0x2e1f3364,0xb1a831a8,0xb364ae1f
.long 0x34008000,0x31a831a8,0x80003400,0xb1a831a8,0x34008000,0x33642e1f,0x31a831a8,0x2e1f3364
.long 0x34008000,0x34008000,0x34008000,0x34008000,0x0000b400,0xae1fb364,0xb1a8b1a8,0xb364ae1f
.long 0xb4008000,0xb1a831a8,0x80003400,0x31a831a8,0x80003400,0x33642e1f,0x31a8b1a8,0xae1fb364
.long 0x34008000,0x0000b400,0xb4008000,0x80003400,0x0000b400,0xb3642e1f,0x31a831a8,0x2e1fb364
.long 0xb4008000,0x31a831a8,0x0000b400,0xb1a831a8,0x80003400,0x2e1fb364,0xb1a831a8,0x3364ae1f
.long 0x34008000,0xb4008000,0x34008000,0xb4008000,0x0000b400,0x2e1f3364,0xb1a8b1a8,0x33642e1f
.long 0xb4008000,0x31a8b1a8,0x80003400,0xb1a8b1a8,0x80003400,0xb364ae1f,0x31a8b1a8,0x2e1f3364
.long 0x34008000,0x80003400,0xb4008000,0x0000b400,0x0000b400,0x3364ae1f,0x31a831a8,0xae1f3364
.long 0xb4008000,0xb1a8b1a8,0x0000b400,0x31a8b1a8,0x80003400,0xae1f3364,0xb1a831a8,0xb3642e1f
.long 0x34008000,0x34008000,0x34008000,0x34008000,0xb4008000,0xb3642e1f,0xb1a831a8,0xae1f3364
.long 0x34008000,0x31a8b1a8,0x0000b400,0xb1a8b1a8,0xb4008000,0xae1f3364,0x31a831a8,0x3364ae1f
.long 0x34008000,0x0000b400,0xb4008000,0x80003400,0xb4008000,0x2e1f3364,0x31a8b1a8,0xb364ae1f
.long 0x34008000,0xb1a8b1a8,0x80003400,0x31a8b1a8,0xb4008000,0x33642e1f,0xb1a8b1a8,0x2e1f3364
.long 0x34008000,0xb4008000,0x34008000,0xb4008000,0xb4008000,0x3364ae1f,0xb1a831a8,0x2e1fb364
.long 0x34008000,0xb1a831a8,0x0000b400,0x31a831a8,0xb4008000,0x2e1fb364,0x31a831a8,0xb3642e1f
.long 0x34008000,0x80003400,0xb4008000,0x0000b400,0xb4008000,0xae1fb364,0x31a8b1a8,0x33642e1f
.long 0x34008000,0x31a831a8,0x80003400,0xb1a831a8,0xb4008000,0xb364ae1f,0xb1a8b1a8,0xae1fb364
.long 0x34008000,0x34008000,0x34008000,0x34008000,0x80003400,0x2e1f3364,0x31a831a8,0x33642e1f
.long 0xb4008000,0xb1a831a8,0x80003400,0x31a831a8,0x0000b400,0xb364ae1f,0xb1a831a8,0x2e1f3364
.long 0x34008000,0x0000b400,0xb4008000,0x80003400,0x80003400,0x3364ae1f,0xb1a8b1a8,0xae1f3364
.long 0xb4008000,0x31a831a8,0x0000b400,0xb1a831a8,0x0000b400,0xae1f3364,0x31a8b1a8,0xb3642e1f
.long 0x34008000,0xb4008000,0x34008000,0xb4008000,0x80003400,0xae1fb364,0x31a831a8,0xb364ae1f
.long 0xb4008000,0x31a8b1a8,0x80003400,0xb1a8b1a8,0x0000b400,0x33642e1f,0xb1a831a8,0xae1fb364
.long 0x34008000,0x80003400,0xb4008000,0x0000b400,0x80003400,0xb3642e1f,0xb1a8b1a8,0x2e1fb364
.long 0xb4008000,0xb1a8b1a8,0x0000b400,0x31a8b1a8,0x0000b400,0x2e1fb364,0x31a8b1a8,0x3364ae1f
.long 0x3f800000,0x3f800000,0x3f800000,0x3f800000,0x3f800000,0x3f7ff98e,0x3f7fe638,0x3f7fc600
.long 0x3f800000,0x3f7fe638,0x3f7f98e6,0x3f7f181a,0x3f800000,0x3f7fc600,0x3f7f181a,0x3f7df69c
.long 0x3f800000,0x3f7f98e6,0x3f7e63ec,0x3f7c620b,0x3f800000,0x3f7f5eee,0x3f7d7c83,0x3f7a5b1d
.long 0x3f800000,0x3f7f181a,0x3f7c620b,0x3f77e2bd,0x3f800000,0x3f7ec46d,0x3f7b14be,0x3f74fa0b
.long 0x3f800000,0x3f7e63ec,0x3f7994e0,0x3f71a257,0x3f800000,0x3f7df69c,0x3f77e2bd,0x3f6ddd24
.long 0x3f800000,0x3f7d7c83,0x3f75fead,0x3f69ac2a,0x3f800000,0x3f7cf5a5,0x3f73e912,0x3f65114d
.long 0x3f800000,0x3f7c620b,0x3f71a257,0x3f600ea4,0x3f800000,0x3f7bc1bb,0x3f6f2af0,0x3f5aa675
.long 0x3f800000,0x3f7b14be,0x3f6c835e,0x3f54db31,0x3f800000,0x3f7a5b1d,0x3f69ac2a,0x3f4eaf7a
.long 0x3f800000,0x3f800000,0x3f800000,0x3f800000,0x3f7f98e6,0x3f7f5eee,0x3f7f181a,0x3f7ec46d
.long 0x3f7e63ec,0x3f7d7c83,0x3f7c620b,0x3f7b14be,0x3f7c620b,0x3f7a5b1d,0x3f77e2bd,0x3f74fa0b
.long 0x3f7994e0,0x3f75fead,0x3f71a257,0x3f6c835e,0x3f75fead,0x3f706cb1,0x3f69ac2a,0x3f61c598
.long 0x3f71a257,0x3f69ac2a,0x3f600ea4,0x3f54db31,0x3f6c835e,0x3f61c598,0x3f54db31,0x3f45e403
.long 0x3f66a5e5,0x3f58c2eb,0x3f48261c,0x3f3504f3,0x3f600ea4,0x3f4eaf7a,0x3f3a0669,0x3f226799
.long 0x3f58c2eb,0x3f4397f4,0x3f2a95b0,0x3f0e39da,0x3f50c899,0x3f378a4d,0x3f19efeb,0x3ef15aea
.long 0x3f48261c,0x3f2a95b0,0x3f083341,0x3ec3ef15,0x3f3ee268,0x3f1cca6b,0x3eeaffac,0x3e94a031
.long 0x3f3504f3,0x3f0e39da,0x3ec3ef15,0x3e47c5c2,0x3f2a95b0,0x3efdec9f,0x3e9b7b85,0x3dc8bd36
.long 0x3f800000,0x3f800000,0x3f800000,0x3f800000,0x3f7e63ec,0x3f7df69c,0x3f7d7c83,0x3f7cf5a5
.long 0x3f7994e0,0x3f77e2bd,0x3f75fead,0x3f73e912,0x3f71a257,0x3f6ddd24,0x3f69ac2a,0x3f65114d
.long 0x3f66a5e5,0x3f600ea4,0x3f58c2eb,0x3f50c899,0x3f58c2eb,0x3f4eaf7a,0x3f4397f4,0x3f378a4d
.long 0x3f48261c,0x3f3a0669,0x3f2a95b0,0x3f19efeb,0x3f3504f3,0x3f226799,0x3f0e39da,0x3ef15aea
.long 0x3f1f9d07,0x3f083341,0x3ede2602,0x3ea91a56,0x3f083341,0x3ed7a83d,0x3e9b7b85,0x3e39aaee
.long 0x3ede2602,0x3e9b7b85,0x3e2b86c0,0x3ce5c143,0x3ea91a56,0x3e39aaee,0x3ce5c143,0xbe00e941
.long 0x3e63dc87,0x3d65aa20,0xbde54da2,0xbe8dbd62,0x3de54da2,0xbd8f7f7c,0xbe7fc568,0xbed7a83d
.long 0x00000000,0xbe47c5c2,0xbec3ef15,0xbf0e39da,0xbde54da2,0xbea24f04,0xbf02113a,0xbf2d3eb9
.long 0x3f800000,0x3f800000,0x3f800000,0x3f800000,0x3f7c620b,0x3f7bc1bb,0x3f7b14be,0x3f7a5b1d
.long 0x3f71a257,0x3f6f2af0,0x3f6c835e,0x3f69ac2a,0x3f600ea4,0x3f5aa675,0x3f54db31,0x3f4eaf7a
.long 0x3f48261c,0x3f3ee268,0x3f3504f3,0x3f2a95b0,0x3f2a95b0,0x3f1cca6b,0x3f0e39da,0x3efdec9f
.long 0x3f083341,0x3eeaffac,0x3ec3ef15,0x3e9b7b85,0x3ec3ef15,0x3e94a031,0x3e47c5c2,0x3dc8bd36
.long 0x3e63dc87,0x3de54da2,0x00000000,0xbde54da2,0x3d65aa20,0xbd8f7f7c,0xbe47c5c2,0xbea24f04
.long 0xbde54da2,0xbe7fc568,0xbec3ef15,0xbf02113a,0xbe8dbd62,0xbed7a83d,0xbf0e39da,0xbf2d3eb9
.long 0xbede2602,0xbf1423cd,0xbf3504f3,0xbf50c899,0xbf1423cd,0xbf378a4d,0xbf54db31,0xbf6b1db0
.long 0xbf3504f3,0xbf54db31,0xbf6c835e,0xbf7b14be,0xbf50c899,0xbf6b1db0,0xbf7b14be,0xbf7ff98e
.long 0x00000000,0x00000000,0x00000000,0x00000000,0x00000000,0x3c65c70c,0x3ce5c143,0x3d2c49b7
.long 0x00000000,0x3ce5c143,0x3d65aa20,0x3dac22ae,0x00000000,0x3d2c49b7,0x3dac22ae,0x3e00e941
.long 0x00000000,0x3d65aa20,0x3de54da2,0x3e2b86c0,0x00000000,0x3d8f7f7c,0x3e0f2533,0x3e55d687
.long 0x00000000,0x3dac22ae,0x3e2b86c0,0x3e7fc568,0x00000000,0x3dc8bd36,0x3e47c5c2,0x3e94a031
.long 0x00000000,0x3de54da2,0x3e63dc87,0x3ea91a56,0x00000000,0x3e00e941,0x3e7fc568,0x3ebd47db
.long 0x00000000,0x3e0f2533,0x3e8dbd62,0x3ed11f9b,0x00000000,0x3e1d59f0,0x3e9b7b85,0x3ee49898
.long 0x00000000,0x3e2b86c0,0x3ea91a56,0x3ef7aa01,0x00000000,0x3e39aaee,0x3eb69719,0x3f052598
.long 0x00000000,0x3e47c5c2,0x3ec3ef15,0x3f0e39da,0x00000000,0x3e55d687,0x3ed11f9b,0x3f170daa
.long 0x00000000,0x00000000,0x00000000,0x00000000,0x3d65aa20,0x3d8f7f7c,0x3dac22ae,0x3dc8bd36
.long 0x3de54da2,0x3e0f2533,0x3e2b86c0,0x3e47c5c2,0x3e2b86c0,0x3e55d687,0x3e7fc568,0x3e94a031
.long 0x3e63dc87,0x3e8dbd62,0x3ea91a56,0x3ec3ef15,0x3e8dbd62,0x3eafdd25,0x3ed11f9b,0x3ef15aea
.long 0x3ea91a56,0x3ed11f9b,0x3ef7aa01,0x3f0e39da,0x3ec3ef15,0x3ef15aea,0x3f0e39da,0x3f226799
.long 0x3ede2602,0x3f083341,0x3f1f9d07,0x3f3504f3,0x3ef7aa01,0x3f170daa,0x3f2fdf08,0x3f45e403
.long 0x3f083341,0x3f2529fe,0x3f3ee268,0x3f54db31,0x3f1423cd,0x3f32767c,0x3f4c8bf3,0x3f61c598
.long 0x3f1f9d07,0x3f3ee268,0x3f58c2eb,0x3f6c835e,0x3f2a95b0,0x3f4a5e20,0x3f63712c,0x3f74fa0b
.long 0x3f3504f3,0x3f54db31,0x3f6c835e,0x3f7b14be,0x3f3ee268,0x3f5e4c69,0x3f73e912,0x3f7ec46d
.long 0x00000000,0x00000000,0x00000000,0x00000000,0x3de54da2,0x3e00e941,0x3e0f2533,0x3e1d59f0
.long 0x3e63dc87,0x3e7fc568,0x3e8dbd62,0x3e9b7b85,0x3ea91a56,0x3ebd47db,0x3ed11f9b,0x3ee49898
.long 0x3ede2602,0x3ef7aa01,0x3f083341,0x3f1423cd,0x3f083341,0x3f170daa,0x3f2529fe,0x3f32767c
.long 0x3f1f9d07,0x3f2fdf08,0x3f3ee268,0x3f4c8bf3,0x3f3504f3,0x3f45e403,0x3f54db31,0x3f61c598
.long 0x3f48261c,0x3f58c2eb,0x3f66a5e5,0x3f71a257,0x3f58c2eb,0x3f682ee0,0x3f73e912,0x3f7bc1bb
.long 0x3f66a5e5,0x3f73e912,0x3f7c620b,0x3f7fe638,0x3f71a257,0x3f7bc1bb,0x3f7fe638,0x3f7df69c
.long 0x3f7994e0,0x3f7f98e6,0x3f7e63ec,0x3f75fead,0x3f7e63ec,0x3f7f5eee,0x3f77e2bd,0x3f682ee0
.long 0x3f800000,0x3f7b14be,0x3f6c835e,0x3f54db31,0x3f7e63ec,0x3f72cbd1,0x3f5c7efc,0x3f3c7927
.long 0x00000000,0x00000000,0x00000000,0x00000000,0x3e2b86c0,0x3e39aaee,0x3e47c5c2,0x3e55d687
.long 0x3ea91a56,0x3eb69719,0x3ec3ef15,0x3ed11f9b,0x3ef7aa01,0x3f052598,0x3f0e39da,0x3f170daa
.long 0x3f1f9d07,0x3f2a95b0,0x3f3504f3,0x3f3ee268,0x3f3ee268,0x3f4a5e20,0x3f54db31,0x3f5e4c69
.long 0x3f58c2eb,0x3f63712c,0x3f6c835e,0x3f73e912,0x3f6c835e,0x3f74fa0b,0x3f7b14be,0x3f7ec46d
.long 0x3f7994e0,0x3f7e63ec,0x3f800000,0x3f7e63ec,0x3f7f98e6,0x3f7f5eee,0x3f7b14be,0x3f72cbd1
.long 0x3f7e63ec,0x3f77e2bd,0x3f6c835e,0x3f5c7efc,0x3f75fead,0x3f682ee0,0x3f54db31,0x3f3c7927
.long 0x3f66a5e5,0x3f50c899,0x3f3504f3,0x3f1423cd,0x3f50c899,0x3f32767c,0x3f0e39da,0x3eca8c72
.long 0x3f3504f3,0x3f0e39da,0x3ec3ef15,0x3e47c5c2,0x3f1423cd,0x3eca8c72,0x3e47c5c2,0xbc65c70c
.long 0x80003400,0x80003400,0x80003400,0x80003400,0x80003400,0xae1f3364,0xb1a831a8,0xb3642e1f
.long 0x80003400,0xb1a831a8,0xb4000000,0xb1a8b1a8,0x80003400,0xb3642e1f,0xb1a8b1a8,0x2e1fb364
.long 0x80003400,0xb4000000,0x8000b400,0x34008000,0x80003400,0xb364ae1f,0x31a8b1a8,0x2e1f3364
.long 0x80003400,0xb1a8b1a8,0x34008000,0xb1a831a8,0x80003400,0xae1fb364,0x31a831a8,0xb364ae1f
.long 0x80003400,0x8000b400,0x80003400,0x8000b400,0x80003400,0x2e1fb364,0xb1a831a8,0x3364ae1f
.long 0x80003400,0x31a8b1a8,0xb4000000,0x31a831a8,0x80003400,0x3364ae1f,0xb1a8b1a8,0xae1f3364
.long 0x80003400,0x34008000,0x8000b400,0xb4000000,0x80003400,0x33642e1f,0x31a8b1a8,0xae1fb364
.long 0x80003400,0x31a831a8,0x34008000,0x31a8b1a8,0x80003400,0x2e1f3364,0x31a831a8,0x33642e1f
.long 0x80003400,0x80003400,0x80003400,0x80003400,0xb4000000,0xb364ae1f,0xb1a8b1a8,0xae1fb364
.long 0x8000b400,0x31a8b1a8,0x34008000,0x31a831a8,0x34008000,0x2e1f3364,0xb1a831a8,0xb364ae1f
.long 0x80003400,0xb4000000,0x8000b400,0x34008000,0xb4000000,0x2e1fb364,0x31a831a8,0xb3642e1f
.long 0x8000b400,0x31a831a8,0xb4000000,0x31a8b1a8,0x34008000,0xb3642e1f,0x31a8b1a8,0xae1f3364
.long 0x80003400,0x8000b400,0x80003400,0x8000b400,0xb4000000,0x33642e1f,0xb1a8b1a8,0x2e1f3364
.long 0x8000b400,0xb1a831a8,0x34008000,0xb1a8b1a8,0x34008000,0xae1fb364,0xb1a831a8,0x33642e1f
.long 0x80003400,0x34008000,0x8000b400,0xb4000000,0xb4000000,0xae1f3364,0x31a831a8,0x3364ae1f
.long 0x8000b400,0xb1a8b1a8,0xb4000000,0xb1a831a8,0x34008000,0x3364ae1f,0x31a8b1a8,0x2e1fb364
.long 0x80003400,0x80003400,0x80003400,0x80003400,0x8000b400,0x2e1fb364,0x31a8b1a8,0x3364ae1f
.long 0x80003400,0xb1a831a8,0xb4000000,0xb1a8b1a8,0x8000b400,0x3364ae1f,0x31a831a8,0xae1f3364
.long 0x80003400,0xb4000000,0x8000b400,0x34008000,0x8000b400,0x33642e1f,0xb1a831a8,0xae1fb364
.long 0x80003400,0xb1a8b1a8,0x34008000,0xb1a831a8,0x8000b400,0x2e1f3364,0xb1a8b1a8,0x33642e1f
.long 0x80003400,0x8000b400,0x80003400,0x8000b400,0x8000b400,0xae1f3364,0x31a8b1a8,0xb3642e1f
.long 0x80003400,0x31a8b1a8,0xb4000000,0x31a831a8,0x8000b400,0xb3642e1f,0x31a831a8,0x2e1fb364
.long 0x80003400,0x34008000,0x8000b400,0xb4000000,0x8000b400,0xb364ae1f,0xb1a831a8,0x2e1f3364
.long 0x80003400,0x31a831a8,0x34008000,0x31a8b1a8,0x8000b400,0xae1fb364,0xb1a8b1a8,0xb364ae1f
.long 0x80003400,0x80003400,0x80003400,0x80003400,0x34008000,0x33642e1f,0x31a831a8,0x2e1f3364
.long 0x8000b400,0x31a8b1a8,0x34008000,0x31a831a8,0xb4000000,0xae1fb364,0x31a8b1a8,0x33642e1f
.long 0x80003400,0xb4000000,0x8000b400,0x34008000,0x34008000,0xae1f3364,0xb1a8b1a8,0x3364ae1f
.long 0x8000b400,0x31a831a8,0xb4000000,0x31a8b1a8,0xb4000000,0x3364ae1f,0xb1a831a8,0x2e1fb364
.long 0x80003400,0x8000b400,0x80003400,0x8000b400,0x34008000,0xb364ae1f,0x31a831a8,0xae1fb364
.long 0x8000b400,0xb1a831a8,0x34008000,0xb1a8b1a8,0xb4000000,0x2e1f3364,0x31a8b1a8,0xb364ae1f
.long 0x80003400,0x34008000,0x8000b400,0xb4000000,0x34008000,0x2e1fb364,0xb1a8b1a8,0xb3642e1f
.long 0x8000b400,0xb1a8b1a8,0xb4000000,0xb1a831a8,0xb4000000,0xb3642e1f,0xb1a831a8,0xae1f3364
.long 0x34000000,0x34000000,0x34000000,0x34000000,0x34000000,0x33642e1f,0x31a831a8,0x2e1f3364
.long 0x34000000,0x31a831a8,0x00003400,0xb1a831a8,0x34000000,0x2e1f3364,0xb1a831a8,0xb364ae1f
.long 0x34000000,0x00003400,0xb4000000,0x8000b400,0x34000000,0xae1f3364,0xb1a8b1a8,0x3364ae1f
.long 0x34000000,0xb1a831a8,0x8000b400,0x31a831a8,0x34000000,0xb3642e1f,0x31a8b1a8,0xae1f3364
.long 0x34000000,0xb4000000,0x34000000,0xb4000000,0x34000000,0xb364ae1f,0x31a831a8,0xae1fb364
.long 0x34000000,0xb1a8b1a8,0x00003400,0x31a8b1a8,0x34000000,0xae1fb364,0xb1a831a8,0x33642e1f
.long 0x34000000,0x8000b400,0xb4000000,0x00003400,0x34000000,0x2e1fb364,0xb1a8b1a8,0xb3642e1f
.long 0x34000000,0x31a8b1a8,0x8000b400,0xb1a8b1a8,0x34000000,0x3364ae1f,0x31a8b1a8,0x2e1fb364
.long 0x34000000,0x34000000,0x34000000,0x34000000,0x00003400,0xae1f3364,0xb1a831a8,0xb3642e1f
.long 0xb4000000,0xb1a8b1a8,0x8000b400,0x31a8b1a8,0x8000b400,0x3364ae1f,0x31a831a8,0xae1f3364
.long 0x34000000,0x00003400,0xb4000000,0x8000b400,0x00003400,0xb364ae1f,0x31a8b1a8,0x2e1f3364
.long 0xb4000000,0x31a8b1a8,0x00003400,0xb1a8b1a8,0x8000b400,0x2e1f3364,0xb1a8b1a8,0x33642e1f
.long 0x34000000,0xb4000000,0x34000000,0xb4000000,0x00003400,0x2e1fb364,0xb1a831a8,0x3364ae1f
.long 0xb4000000,0x31a831a8,0x8000b400,0xb1a831a8,0x8000b400,0xb3642e1f,0x31a831a8,0x2e1fb364
.long 0x34000000,0x8000b400,0xb4000000,0x00003400,0x00003400,0x33642e1f,0x31a8b1a8,0xae1fb364
.long 0xb4000000,0xb1a831a8,0x00003400,0x31a831a8,0x8000b400,0xae1fb364,0xb1a8b1a8,0xb364ae1f
.long 0x34000000,0x34000000,0x34000000,0x34000000,0xb4000000,0xb364ae1f,0xb1a8b1a8,0xae1fb364
.long 0x34000000,0x31a831a8,0x00003400,0xb1a831a8,0xb4000000,0xae1fb364,0x31a8b1a8,0x33642e1f
.long 0x34000000,0x00003400,0xb4000000,0x8000b400,0xb4000000,0x2e1fb364,0x31a831a8,0xb3642e1f
.long 0x34000000,0xb1a831a8,0x8000b400,0x31a831a8,0xb4000000,0x3364ae1f,0xb1a831a8,0x2e1fb364
.long 0x34000000,0xb4000000,0x34000000,0xb4000000,0xb4000000,0x33642e1f,0xb1a8b1a8,0x2e1f3364
.long 0x34000000,0xb1a8b1a8,0x00003400,0x31a8b1a8,0xb4000000,0x2e1f3364,0x31a8b1a8,0xb364ae1f
.long 0x34000000,0x8000b400,0xb4000000,0x00003400,0xb4000000,0xae1f3364,0x31a831a8,0x3364ae1f
.long 0x34000000,0x31a8b1a8,0x8000b400,0xb1a8b1a8,0xb4000000,0xb3642e1f,0xb1a831a8,0xae1f3364
.long 0x34000000,0x34000000,0x34000000,0x34000000,0x8000b400,0x2e1fb364,0x31a8b1a8,0x3364ae1f
.long 0xb4000000,0xb1a8b1a8,0x8000b400,0x31a8b1a8,0x00003400,0xb3642e1f,0xb1a8b1a8,0x2e1fb364
.long 0x34000000,0x00003400,0xb4000000,0x8000b400,0x8000b400,0x33642e1f,0xb1a831a8,0xae1fb364
.long 0xb4000000,0x31a8b1a8,0x00003400,0xb1a8b1a8,0x00003400,0xae1fb364,0x31a831a8,0xb364ae1f
.long 0x34000000,0xb4000000,0x34000000,0xb4000000,0x8000b400,0xae1f3364,0x31a8b1a8,0xb3642e1f
.long 0xb4000000,0x31a831a8,0x8000b400,0xb1a831a8,0x00003400,0x3364ae1f,0xb1a8b1a8,0xae1f3364
.long 0x34000000,0x8000b400,0xb4000000,0x00003400,0x8000b400,0xb364ae1f,0xb1a831a8,0x2e1f3364
.long 0xb4000000,0xb1a831a8,0x00003400,0x31a831a8,0x00003400,0x2e1f3364,0x31a831a8,0x33642e1f
.long 0x8000320c,0x8000360c,0x8000360c,0x8000360c,0x8000320c,0xad6235e5,0xb13f3573,0xb38b34ba
.long 0x8000320c,0xb13f3573,0xb4ba338b,0xb5e52d62,0x8000320c,0xb38b34ba,0xb5e52d62,0xb573b13f
.long 0x8000320c,0xb4ba338b,0xb5e5ad62,0xb13fb573,0x8000320c,0xb573313f,0xb4bab38b,0x2d62b5e5
.long 0x8000320c,0xb5e52d62,0xb13fb573,0x34bab38b,0x8000320c,0xb60c0000,0x8000b60c,0x360c8000
.long 0x8000320c,0xb5e5ad62,0x313fb573,0x34ba338b,0x8000320c,0xb573b13f,0x34bab38b,0x2d6235e5
.long 0x8000320c,0xb4bab38b,0x35e5ad62,0xb13f3573,0x8000320c,0xb38bb4ba,0x35e52d62,0xb573313f
.long 0x8000320c,0xb13fb573,0x34ba338b,0xb5e5ad62,0x8000320c,0xad62b5e5,0x313f3573,0xb38bb4ba
.long 0x8000320c,0x8000b60c,0x8000360c,0x8000b60c,0x8000320c,0x2d62b5e5,0xb13f3573,0x338bb4ba
.long 0x8000360c,0x8000360c,0x8000360c,0x8000360c,0xb4ba338b,0xb573313f,0xb5e52d62,0xb60c0000
.long 0xb5e5ad62,0xb4bab38b,0xb13fb573,0x8000b60c,0xb13fb573,0x2d62b5e5,0x34bab38b,0x360c8000
.long 0x313fb573,0x35e5ad62,0x34ba338b,0x8000360c,0x35e5ad62,0x338b34ba,0xb13f3573,0xb60c0000
.long 0x34ba338b,0xb13f3573,0xb5e5ad62,0x8000b60c,0x8000360c,0xb60c0000,0x8000b60c,0x360c8000
.long 0xb4ba338b,0xb13fb573,0x35e5ad62,0x8000360c,0xb5e5ad62,0x338bb4ba,0x313f3573,0xb60c0000
.long 0xb13fb573,0x35e52d62,0xb4ba338b,0x8000b60c,0x313fb573,0x2d6235e5,0xb4bab38b,0x360c8000
.long 0x35e5ad62,0xb4ba338b,0x313fb573,0x8000360c,0x34ba338b,0xb573b13f,0x35e52d62,0xb60c0000
.long 0x8000360c,0x8000b60c,0x8000360c,0x8000b60c,0xb4ba338b,0x3573b13f,0xb5e52d62,0x360c8000
.long 0x8000360c,0x8000360c,0x8000360c,0x8000360c,0xb5e5ad62,0xb573b13f,0xb4bab38b,0xb38bb4ba
.long 0x313fb573,0x34bab38b,0x35e5ad62,0x35e52d62,0x34ba338b,0x2d6235e5,0xb13f3573,0xb573313f
.long 0xb4ba338b,0xb5e5ad62,0xb13fb573,0x313fb573,0xb13fb573,0x338bb4ba,0x35e52d62,0x2d6235e5
.long 0x35e5ad62,0x313f3573,0xb4ba338b,0xb4bab38b,0x8000360c,0xb60c0000,0x8000b60c,0x360c8000
.long 0xb5e5ad62,0x313fb573,0x34ba338b,0xb4ba338b,0x313fb573,0x338b34ba,0xb5e52d62,0x2d62b5e5
.long 0x34ba338b,0xb5e52d62,0x313fb573,0x313f3573,0xb4ba338b,0x2d62b5e5,0x313f3573,0xb573b13f
.long 0xb13fb573,0x34ba338b,0xb5e5ad62,0x35e5ad62,0x35e5ad62,0xb573313f,0x34bab38b,0xb38b34ba
.long 0x8000360c,0x8000b60c,0x8000360c,0x8000b60c,0xb5e5ad62,0x3573313f,0xb4bab38b,0x338b34ba
.long 0x8000360c,0x8000360c,0x8000320c,0x00000000,0xb13fb573,0xad62b5e5,0x8000b20c,0x00000000
.long 0x34ba338b,0x313f3573,0x8000320c,0x00000000,0xb5e5ad62,0xb38bb4ba,0x8000b20c,0x00000000
.long 0x35e5ad62,0x34ba338b,0x8000320c,0x00000000,0xb4ba338b,0xb573b13f,0x8000b20c,0x00000000
.long 0x313fb573,0x35e52d62,0x8000320c,0x00000000,0x8000360c,0xb60c0000,0x8000b20c,0x00000000
.long 0xb13fb573,0x35e5ad62,0x8000320c,0x00000000,0x34ba338b,0xb573313f,0x8000b20c,0x00000000
.long 0xb5e5ad62,0x34bab38b,0x8000320c,0x00000000,0x35e5ad62,0xb38b34ba,0x8000b20c,0x00000000
.long 0xb4ba338b,0x313fb573,0x8000320c,0x00000000,0x313fb573,0xad6235e5,0x8000b20c,0x00000000
.long 0x8000360c,0x8000b60c,0x8000320c,0x00000000,0xb13fb573,0x2d6235e5,0x8000b20c,0x00000000
.long 0x8000320c,0x313fb573,0xb4ba338b,0x35e5ad62,0x8000320c,0x338bb4ba,0xb5e52d62,0x3573313f
.long 0x8000320c,0x34bab38b,0xb5e5ad62,0x313f3573,0x8000320c,0x3573b13f,0xb4bab38b,0xad6235e5
.long 0x8000320c,0x35e5ad62,0xb13fb573,0xb4ba338b,0x8000320c,0x360c8000,0x8000b60c,0xb60c0000
.long 0x8000320c,0x35e52d62,0x313fb573,0xb4bab38b,0x8000320c,0x3573313f,0x34bab38b,0xad62b5e5
.long 0x8000320c,0x34ba338b,0x35e5ad62,0x313fb573,0x8000320c,0x338b34ba,0x35e52d62,0x3573b13f
.long 0x8000320c,0x313f3573,0x34ba338b,0x35e52d62,0x8000320c,0x2d6235e5,0x313f3573,0x338b34ba
.long 0x00000000,0x00000000,0x00000000,0x00000000,0x00000000,0x00000000,0x00000000,0x00000000
.long 0x00000000,0x00000000,0x00000000,0x00000000,0x00000000,0x00000000,0x00000000,0x00000000
.long 0xb5e5ad62,0x34ba338b,0xb13fb573,0x8000360c,0xb13fb573,0xad6235e5,0x34bab38b,0xb60c0000
.long 0x313fb573,0xb5e52d62,0x34ba338b,0x8000b60c,0x35e5ad62,0xb38bb4ba,0xb13f3573,0x360c8000
.long 0x34ba338b,0x313fb573,0xb5e5ad62,0x8000360c,0x8000360c,0x360c8000,0x8000b60c,0xb60c0000
.long 0xb4ba338b,0x313f3573,0x35e5ad62,0x8000b60c,0xb5e5ad62,0xb38b34ba,0x313f3573,0x360c8000
.long 0xb13fb573,0xb5e5ad62,0xb4ba338b,0x8000360c,0x313fb573,0xad62b5e5,0xb4bab38b,0xb60c0000
.long 0x35e5ad62,0x34bab38b,0x313fb573,0x8000b60c,0x34ba338b,0x3573313f,0x35e52d62,0x360c8000
.long 0x00000000,0x00000000,0x00000000,0x00000000,0x00000000,0x00000000,0x00000000,0x00000000
.long 0x00000000,0x00000000,0x00000000,0x00000000,0x00000000,0x00000000,0x00000000,0x00000000
.long 0x313fb573,0xb4ba338b,0x35e5ad62,0xb5e5ad62,0x34ba338b,0xad62b5e5,0xb13f3573,0x3573b13f
.long 0xb4ba338b,0x35e52d62,0xb13fb573,0xb13f3573,0xb13fb573,0xb38b34ba,0x35e52d62,0xad62b5e5
.long 0x35e5ad62,0xb13fb573,0xb4ba338b,0x34ba338b,0x8000360c,0x360c8000,0x8000b60c,0xb60c0000
.long 0xb5e5ad62,0xb13f3573,0x34ba338b,0x34bab38b,0x313fb573,0xb38bb4ba,0xb5e52d62,0xad6235e5
.long 0x34ba338b,0x35e5ad62,0x313fb573,0xb13fb573,0xb4ba338b,0xad6235e5,0x313f3573,0x3573313f
.long 0xb13fb573,0xb4bab38b,0xb5e5ad62,0xb5e52d62,0x35e5ad62,0x3573b13f,0x34bab38b,0x338bb4ba
.long 0x00000000,0x00000000,0x00000000,0x00000000,0x00000000,0x00000000,0x00000000,0x00000000
.long 0x00000000,0x00000000,0x00000000,0x00000000,0x00000000,0x00000000,0x00000000,0x00000000
.long 0x34ba338b,0xb13fb573,0x8000320c,0x00000000,0xb5e5ad62,0x338b34ba,0x8000b20c,0x00000000
.long 0x35e5ad62,0xb4bab38b,0x8000320c,0x00000000,0xb4ba338b,0x3573313f,0x8000b20c,0x00000000
.long 0x313fb573,0xb5e5ad62,0x8000320c,0x00000000,0x8000360c,0x360c8000,0x8000b20c,0x00000000
.long 0xb13fb573,0xb5e52d62,0x8000320c,0x00000000,0x34ba338b,0x3573b13f,0x8000b20c,0x00000000
.long 0xb5e5ad62,0xb4ba338b,0x8000320c,0x00000000,0x35e5ad62,0x338bb4ba,0x8000b20c,0x00000000
.long 0xb4ba338b,0xb13f3573,0x8000320c,0x00000000,0x313fb573,0x2d62b5e5,0x8000b20c,0x00000000
.long 0x00000000,0x00000000,0x00000000,0x00000000,0x00000000,0x00000000,0x00000000,0x00000000
.long 0x00000000,0x00000000,0x00000000,0x00000000,0x00000000,0x00000000,0x00000000,0x00000000
.long 0x3f800000,0x3f800000,0x3f800000,0x3f800000,0x3f800000,0x3f7fec43,0x3f7fb10f,0x3f7f4e6d
.long 0x3f800000,0x3f7fb10f,0x3f7ec46d,0x3f7d3aac,0x3f800000,0x3f7f4e6d,0x3f7d3aac,0x3f79c79d
.long 0x3f800000,0x3f7ec46d,0x3f7b14be,0x3f74fa0b,0x3f800000,0x3f7e1324,0x3f7853f8,0x3f6ed89e
.long 0x3f800000,0x3f7d3aac,0x3f74fa0b,0x3f676bd8,0x3f800000,0x3f7c3b28,0x3f710908,0x3f5ebe05
.long 0x3f800000,0x3f7b14be,0x3f6c835e,0x3f54db31,0x3f800000,0x3f79c79d,0x3f676bd8,0x3f49d112
.long 0x3f800000,0x3f7853f8,0x3f61c598,0x3f3daef9,0x3f800000,0x3f76ba07,0x3f5b941a,0x3f3085bb
.long 0x3f800000,0x3f74fa0b,0x3f54db31,0x3f226799,0x3f800000,0x3f731447,0x3f4d9f02,0x3f13682a
.long 0x3f800000,0x3f710908,0x3f45e403,0x3f039c3d,0x3f800000,0x3f6ed89e,0x3f3daef9,0x3ee63375
.long 0x3f800000,0x3f800000,0x3f800000,0x3f800000,0x3f7ec46d,0x3f7e1324,0x3f7d3aac,0x3f7c3b28
.long 0x3f7b14be,0x3f7853f8,0x3f74fa0b,0x3f710908,0x3f74fa0b,0x3f6ed89e,0x3f676bd8,0x3f5ebe05
.long 0x3f6c835e,0x3f61c598,0x3f54db31,0x3f45e403,0x3f61c598,0x3f514d3d,0x3f3daef9,0x3f273656
.long 0x3f54db31,0x3f3daef9,0x3f226799,0x3f039c3d,0x3f45e403,0x3f273656,0x3f039c3d,0x3eb8442a
.long 0x3f3504f3,0x3f0e39da,0x3ec3ef15,0x3e47c5c2,0x3f226799,0x3ee63375,0x3e78cfcc,0x3cc90ab0
.long 0x3f0e39da,0x3eac7cd4,0x3dc8bd36,0xbe164083,0x3ef15aea,0x3e605c13,0xbd48fb30,0xbea09ae5
.long 0x3ec3ef15,0x3dc8bd36,0xbe47c5c2,0xbef15aea,0x3e94a031,0xbcc90ab0,0xbeac7cd4,0xbf1d7fd1
.long 0x3e47c5c2,0xbe164083,0xbef15aea,0xbf3daef9,0x3dc8bd36,0xbe888e93,0xbf187fc0,0xbf584853
.long 0x3f800000,0x3f800000,0x3f800000,0x3f800000,0x3f7b14be,0x3f79c79d,0x3f7853f8,0x3f76ba07
.long 0x3f6c835e,0x3f676bd8,0x3f61c598,0x3f5b941a,0x3f54db31,0x3f49d112,0x3f3daef9,0x3f3085bb
.long 0x3f3504f3,0x3f226799,0x3f0e39da,0x3ef15aea,0x3f0e39da,0x3ee63375,0x3eac7cd4,0x3e605c13
.long 0x3ec3ef15,0x3e78cfcc,0x3dc8bd36,0xbd48fb30,0x3e47c5c2,0x3cc90ab0,0xbe164083,0xbea09ae5
.long 0x00000000,0xbe47c5c2,0xbec3ef15,0xbf0e39da,0xbe47c5c2,0xbecf7bca,0xbf187fc0,0xbf41d870
.long 0xbec3ef15,0xbf187fc0,0xbf45e403,0xbf676bd8,0xbf0e39da,0xbf41d870,0xbf676bd8,0xbf7c3b28
.long 0xbf3504f3,0xbf61c598,0xbf7b14be,0xbf7ec46d,0xbf54db31,0xbf76ba07,0xbf7fb10f,0xbf6ed89e
.long 0xbf6c835e,0xbf7fb10f,0xbf74fa0b,0xbf4d9f02,0xbf7b14be,0xbf7c3b28,0xbf5b941a,0xbf1d7fd1
.long 0x3f800000,0x3f800000,0x3f800000,0x3f800000,0x3f74fa0b,0x3f731447,0x3f710908,0x3f6ed89e
.long 0x3f54db31,0x3f4d9f02,0x3f45e403,0x3f3daef9,0x3f226799,0x3f13682a,0x3f039c3d,0x3ee63375
.long 0x3ec3ef15,0x3e94a031,0x3e47c5c2,0x3dc8bd36,0x3dc8bd36,0xbcc90ab0,0xbe164083,0xbe888e93
.long 0xbe47c5c2,0xbeac7cd4,0xbef15aea,0xbf187fc0,0xbef15aea,0xbf1d7fd1,0xbf3daef9,0xbf584853
.long 0xbf3504f3,0xbf54db31,0xbf6c835e,0xbf7b14be,0xbf61c598,0xbf76ba07,0xbf7fb10f,0xbf7c3b28
.long 0xbf7b14be,0xbf7fb10f,0xbf74fa0b,0xbf5b941a,0xbf7ec46d,0xbf6ed89e,0xbf4d9f02,0xbf1d7fd1
.long 0xbf6c835e,0xbf45e403,0xbf0e39da,0xbe94a031,0xbf45e403,0xbf08f59b,0xbe78cfcc,0x3d96a905
.long 0xbf0e39da,0xbe78cfcc,0x3dc8bd36,0x3edae880,0xbe94a031,0x3d96a905,0x3edae880,0x3f396842
.long 0x00000000,0x00000000,0x00000000,0x00000000,0x00000000,0x3cc90ab0,0x3d48fb30,0x3d96a905
.long 0x00000000,0x3d48fb30,0x3dc8bd36,0x3e164083,0x00000000,0x3d96a905,0x3e164083,0x3e605c13
.long 0x00000000,0x3dc8bd36,0x3e47c5c2,0x3e94a031,0x00000000,0x3dfab273,0x3e78cfcc,0x3eb8442a
.long 0x00000000,0x3e164083,0x3e94a031,0x3edae880,0x00000000,0x3e2f10a2,0x3eac7cd4,0x3efc5d27
.long 0x00000000,0x3e47c5c2,0x3ec3ef15,0x3f0e39da,0x00000000,0x3e605c13,0x3edae880,0x3f1d7fd1
.long 0x00000000,0x3e78cfcc,0x3ef15aea,0x3f2beb4a,0x00000000,0x3e888e93,0x3f039c3d,0x3f396842
.long 0x00000000,0x3e94a031,0x3f0e39da,0x3f45e403,0x00000000,0x3ea09ae5,0x3f187fc0,0x3f514d3d
.long 0x00000000,0x3eac7cd4,0x3f226799,0x3f5b941a,0x00000000,0x3eb8442a,0x3f2beb4a,0x3f64aa59
.long 0x00000000,0x00000000,0x00000000,0x00000000,0x3dc8bd36,0x3dfab273,0x3e164083,0x3e2f10a2
.long 0x3e47c5c2,0x3e78cfcc,0x3e94a031,0x3eac7cd4,0x3e94a031,0x3eb8442a,0x3edae880,0x3efc5d27
.long 0x3ec3ef15,0x3ef15aea,0x3f0e39da,0x3f226799,0x3ef15aea,0x3f13682a,0x3f2beb4a,0x3f41d870
.long 0x3f0e39da,0x3f2beb4a,0x3f45e403,0x3f5b941a,0x3f226799,0x3f41d870,0x3f5b941a,0x3f6ed89e
.long 0x3f3504f3,0x3f54db31,0x3f6c835e,0x3f7b14be,0x3f45e403,0x3f64aa59,0x3f7853f8,0x3f7fec43
.long 0x3f54db31,0x3f710908,0x3f7ec46d,0x3f7d3aac,0x3f61c598,0x3f79c79d,0x3f7fb10f,0x3f731447
.long 0x3f6c835e,0x3f7ec46d,0x3f7b14be,0x3f61c598,0x3f74fa0b,0x3f7fec43,0x3f710908,0x3f49d112
.long 0x3f7b14be,0x3f7d3aac,0x3f61c598,0x3f2beb4a,0x3f7ec46d,0x3f76ba07,0x3f4d9f02,0x3f08f59b
.long 0x00000000,0x00000000,0x00000000,0x00000000,0x3e47c5c2,0x3e605c13,0x3e78cfcc,0x3e888e93
.long 0x3ec3ef15,0x3edae880,0x3ef15aea,0x3f039c3d,0x3f0e39da,0x3f1d7fd1,0x3f2beb4a,0x3f396842
.long 0x3f3504f3,0x3f45e403,0x3f54db31,0x3f61c598,0x3f54db31,0x3f64aa59,0x3f710908,0x3f79c79d
.long 0x3f6c835e,0x3f7853f8,0x3f7ec46d,0x3f7fb10f,0x3f7b14be,0x3f7fec43,0x3f7d3aac,0x3f731447
.long 0x3f800000,0x3f7b14be,0x3f6c835e,0x3f54db31,0x3f7b14be,0x3f6a09a7,0x3f4d9f02,0x3f273656
.long 0x3f6c835e,0x3f4d9f02,0x3f226799,0x3edae880,0x3f54db31,0x3f273656,0x3edae880,0x3e2f10a2
.long 0x3f3504f3,0x3ef15aea,0x3e47c5c2,0xbdc8bd36,0x3f0e39da,0x3e888e93,0xbd48fb30,0xbeb8442a
.long 0x3ec3ef15,0x3d48fb30,0xbe94a031,0xbf187fc0,0x3e47c5c2,0xbe2f10a2,0xbf039c3d,0xbf49d112
.long 0x00000000,0x00000000,0x00000000,0x00000000,0x3e94a031,0x3ea09ae5,0x3eac7cd4,0x3eb8442a
.long 0x3f0e39da,0x3f187fc0,0x3f226799,0x3f2beb4a,0x3f45e403,0x3f514d3d,0x3f5b941a,0x3f64aa59
.long 0x3f6c835e,0x3f74fa0b,0x3f7b14be,0x3f7ec46d,0x3f7ec46d,0x3f7fec43,0x3f7d3aac,0x3f76ba07
.long 0x3f7b14be,0x3f710908,0x3f61c598,0x3f4d9f02,0x3f61c598,0x3f49d112,0x3f2beb4a,0x3f08f59b
.long 0x3f3504f3,0x3f0e39da,0x3ec3ef15,0x3e47c5c2,0x3ef15aea,0x3e888e93,0x3d48fb30,0xbe2f10a2
.long 0x3e47c5c2,0xbd48fb30,0xbe94a031,0xbf039c3d,0xbdc8bd36,0xbeb8442a,0xbf187fc0,0xbf49d112
.long 0xbec3ef15,0xbf226799,0xbf54db31,0xbf74fa0b,0xbf226799,0xbf584853,0xbf7853f8,0xbf7f4e6d
.long 0xbf54db31,0xbf7853f8,0xbf7ec46d,0xbf676bd8,0xbf74fa0b,0xbf7f4e6d,0xbf676bd8,0xbf3085bb
```
